```python
import torch

def _softmax(x, axis=-1):
    return torch.softmax(x, dim=axis)
def _gelu(x):
    return torch.nn.functional.gelu(x, approximate="tanh")
def _silu(x):
    return torch.nn.functional.silu(x)
def _sigmoid(x):
    return torch.sigmoid(x)
def _layernorm(x, axis=-1, eps=1e-5):
    m = x.mean(dim=axis, keepdim=True)
    v = x.var(dim=axis, keepdim=True, unbiased=False)
    return (x - m) / torch.sqrt(v + eps)
def _scatter_add(tgt, idx, src, axis=0):
    return tgt.clone().index_add_(axis, idx, src)
def _segment_sum(src, seg, n):
    out = torch.zeros((n,) + src.shape[1:], dtype=src.dtype)
    return out.index_add_(0, seg, src)
def _pad(x, pw):
    flat = tuple(v for pair in reversed(pw) for v in pair)
    return torch.nn.functional.pad(x, flat)

kernel_name = 'concat_heads__mha_block_cached__mha_block_cached__near_ridge'

def setup_inputs():

    _w = (lambda a: (lambda t: t.to(torch.bfloat16) if t.is_floating_point() else t)(torch.as_tensor(a)))
    def _A_setup():
        B, Sq, D = 16, 32, 1024
        H, Sk, Dh = 32, 32, 128
        return {
            "x": _w((lambda *s: torch.randn(*s, dtype=torch.bfloat16) * 0.8)(B, Sq, D)),
            "k_cache": _w((lambda *s: torch.randn(*s, dtype=torch.bfloat16) * 0.8)(B, H, Sk, Dh)),
            "v_cache": _w((lambda *s: torch.randn(*s, dtype=torch.bfloat16) * 0.05)(B, H, Sk, Dh)),
            "wq": _w((lambda *s: torch.randn(*s, dtype=torch.bfloat16) * 0.8)(D, H * Dh) * (D ** -0.5)),
            "wo": _w((lambda *s: torch.randn(*s, dtype=torch.bfloat16) * 0.05)(H * Dh, D) * ((H * Dh) ** -0.5)),
        }
    _A_in = _A_setup()

    def _B_setup():
        B, Sq, D = 16, 32, 1024
        H, Sk, Dh = 32, 32, 128
        return {
            "x": _w((lambda *s: torch.randn(*s, dtype=torch.bfloat16) * 0.8)(B, Sq, D)),
            "k_cache": _w((lambda *s: torch.randn(*s, dtype=torch.bfloat16) * 0.8)(B, H, Sk, Dh)),
            "v_cache": _w((lambda *s: torch.randn(*s, dtype=torch.bfloat16) * 0.05)(B, H, Sk, Dh)),
            "wq": _w((lambda *s: torch.randn(*s, dtype=torch.bfloat16) * 0.8)(D, H * Dh) * (D ** -0.5)),
            "wo": _w((lambda *s: torch.randn(*s, dtype=torch.bfloat16) * 0.05)(H * Dh, D) * ((H * Dh) ** -0.5)),
        }
    _B_in = _B_setup()

    return {
        "A_x": _A_in["x"],
        "A_k_cache": _A_in["k_cache"],
        "A_v_cache": _A_in["v_cache"],
        "A_wq": _A_in["wq"],
        "A_wo": _A_in["wo"],
        "B_x": _B_in["x"],
        "B_k_cache": _B_in["k_cache"],
        "B_v_cache": _B_in["v_cache"],
        "B_wq": _B_in["wq"],
        "B_wo": _B_in["wo"],
    }

def reference(A_x, A_k_cache, A_v_cache, A_wq, A_wo, B_x, B_k_cache, B_v_cache, B_wq, B_wo):
    def _A_ref(x, k_cache, v_cache, wq, wo):
        B, Sq, D = x.shape
        H, Dh = 32, 128
        q = (lambda x, *d: x.permute(*d))((x @ wq).reshape(B, Sq, H, Dh), 0, 2, 1, 3)
        scores = torch.einsum("bhqd,bhkd->bhqk", q, k_cache) * (Dh ** -0.5)
        p = _softmax(scores, axis=-1)
        o = torch.einsum("bhqk,bhkd->bhqd", p, v_cache)
        return (lambda x, *d: x.permute(*d))(o, 0, 2, 1, 3).reshape(B, Sq, H * Dh) @ wo

    def _B_ref(x, k_cache, v_cache, wq, wo):
        B, Sq, D = x.shape
        H, Dh = 32, 128
        q = (lambda x, *d: x.permute(*d))((x @ wq).reshape(B, Sq, H, Dh), 0, 2, 1, 3)
        scores = torch.einsum("bhqd,bhkd->bhqk", q, k_cache) * (Dh ** -0.5)
        p = _softmax(scores, axis=-1)
        o = torch.einsum("bhqk,bhkd->bhqd", p, v_cache)
        return (lambda x, *d: x.permute(*d))(o, 0, 2, 1, 3).reshape(B, Sq, H * Dh) @ wo

    a = _A_ref(A_x, A_k_cache, A_v_cache, A_wq, A_wo)
    b = _B_ref(B_x, B_k_cache, B_v_cache, B_wq, B_wo)
    return torch.concatenate([a, b], axis=-1)
```

```asm
; @launch grid=(256,1,1) block=(256,1,1) lds=163840
.amdgcn_target "amdgcn-amd-amdhsa--gfx950"
.text
.globl concat_heads__mha_block_cached__mha_block_cached__near_ridge_kernel
.p2align 8
.type concat_heads__mha_block_cached__mha_block_cached__near_ridge_kernel,@function
concat_heads__mha_block_cached__mha_block_cached__near_ridge_kernel:
    s_cmp_ge_u32 s2, 256
    s_cbranch_scc1 L_end
    s_and_b32 s3, s2, 4
    s_mul_i32 s3, s3, 10
    s_add_u32 s4, s0, s3
    s_addc_u32 s5, s1, 0
    s_load_dwordx8 s[68:75], s[4:5], 0
    s_load_dwordx2 s[76:77], s[4:5], 32
    s_load_dwordx4 s[80:83], s[0:1], 80
    s_load_dwordx2 s[84:85], s[0:1], 96
    s_getpc_b64 s[6:7]
    v_lshlrev_b32 v46, 7, v0
    v_min_u32 v46, L_end-L_pfbase, v46
L_pfbase:
    global_load_dword v251, v46, s[6:7]
    v_lshrrev_b32 v46, 6, v0
    v_and_b32 v1, 63, v0
    v_readfirstlane_b32 s32, v46
    s_and_b32 s29, s2, 3
    s_lshr_b32 s30, s2, 6
    s_bfe_u32 s31, s2, 0x30003
    s_mov_b32 s10, 0x100000
    s_mov_b32 s11, 0x20000
    s_mov_b32 s14, 0x800000
    s_mov_b32 s15, 0x20000
    v_lshrrev_b32 v46, 3, v1
    v_and_b32 v47, 7, v1
    v_lshrrev_b32 v48, 4, v1
    v_xor_b32 v47, v47, v48
    v_lshlrev_b32 v47, 4, v47
    v_lshl_add_u32 v49, v46, 11, v47
    v_lshl_add_u32 v34, v46, 8, v47
    s_lshl_b32 s47, s30, 2
    s_add_u32 s47, s47, s32
    s_lshl_b32 s61, s47, 16
    v_add_u32 v22, s61, v49
    v_xor_b32 v23, 64, v22
    v_add_u32 v24, 30720, v22
    v_add_u32 v25, 46080, v23
    v_add_u32 v23, 15360, v23
    v_and_b32 v51, 15, v1
    v_lshlrev_b32 v50, 2, v48
    v_xor_b32 v50, v51, v50
    v_lshlrev_b32 v50, 4, v50
    v_lshl_add_u32 v50, v48, 13, v50
    s_lshl_b32 s62, s29, 3
    s_add_u32 s62, s62, s31
    s_lshl_b32 s63, s62, 8
    s_lshl_b32 s64, s32, 17
    s_add_u32 s63, s63, s64
    v_add_u32 v26, s63, v50
    v_add_u32 v27, 31744, v26
    v_add_u32 v28, 63488, v26
    v_add_u32 v29, 95232, v26
    v_xor_b32 v28, 32, v28
    v_xor_b32 v29, 32, v29
    s_lshl_b32 s41, s32, 12
    s_add_u32 s42, s41, 16384
    s_add_u32 s34, s30, s31
    s_and_b32 s34, s34, 3
    s_mul_i32 s35, s34, 0x11111111
    s_xor_b32 s35, s35, 0x32103210
    s_add_u32 s36, s35, 0x44440000
    s_add_u32 s37, s35, 0xcccc8888
    s_movk_i32 s40, 272
    s_add_u32 s52, s35, 0x66662222
    s_add_u32 s53, s35, 0xaaaa
    s_and_b32 s53, s53, 0xffff
    s_lshl_b64 s[52:53], s[52:53], 8
    s_and_b32 s34, s34, 1
    s_mul_i32 s34, s34, 0x11
    s_xor_b32 s34, s34, 0x10
    s_or_b32 s52, s52, s34
    s_add_u32 s34, s34, 0xee
    s_lshl_b32 s34, s34, 24
    s_or_b32 s53, s53, s34
    s_cmp_ge_u32 s31, 4
    s_cselect_b64 s[6:7], s[36:37], s[52:53]
    s_cselect_b64 s[36:37], s[52:53], s[36:37]
    s_cselect_b32 s40, 1088, s40
    s_mov_b32 s39, 0
    s_mov_b32 s38, 19
    s_waitcnt lgkmcnt(0)
    s_mov_b64 s[8:9], s[68:69]
    s_mov_b64 s[12:13], s[74:75]
    s_and_b32 s35, s36, 15
    s_add_u32 m0, s41, 0
    s_lshl_b32 s34, s35, 7
    buffer_load_dwordx4 v22, s[8:11], s34 offen offset:0 lds
    buffer_load_dwordx4 v23, s[8:11], s34 offen offset:1024 lds
    s_lshr_b64 s[36:37], s[36:37], 4
    buffer_load_dwordx4 v24, s[8:11], s34 offen offset:2048 lds
    buffer_load_dwordx4 v25, s[8:11], s34 offen offset:3072 lds
    s_add_u32 m0, s42, 0
    s_lshl_b32 s35, s35, 19
    buffer_load_dwordx4 v26, s[12:15], s35 offen offset:0 lds
    buffer_load_dwordx4 v27, s[12:15], s35 offen offset:1024 lds
    buffer_load_dwordx4 v28, s[12:15], s35 offen offset:2048 lds
    buffer_load_dwordx4 v29, s[12:15], s35 offen offset:3072 lds
    s_and_b32 s35, s36, 15
    s_add_u32 m0, s41, 32768
    s_lshl_b32 s34, s35, 7
    buffer_load_dwordx4 v22, s[8:11], s34 offen offset:0 lds
    buffer_load_dwordx4 v23, s[8:11], s34 offen offset:1024 lds
    s_lshr_b64 s[36:37], s[36:37], 4
    buffer_load_dwordx4 v24, s[8:11], s34 offen offset:2048 lds
    buffer_load_dwordx4 v25, s[8:11], s34 offen offset:3072 lds
    s_add_u32 m0, s42, 32768
    s_lshl_b32 s35, s35, 19
    buffer_load_dwordx4 v26, s[12:15], s35 offen offset:0 lds
    buffer_load_dwordx4 v27, s[12:15], s35 offen offset:1024 lds
    buffer_load_dwordx4 v28, s[12:15], s35 offen offset:2048 lds
    buffer_load_dwordx4 v29, s[12:15], s35 offen offset:3072 lds
    s_bfe_u32 s28, s2, 0x10002
    s_lshl_b32 s52, s28, 2
    s_add_u32 s52, s52, s30
    s_lshl_b32 s52, s52, 3
    s_add_u32 s52, s52, s31
    s_xor_b32 s52, s52, 1
    s_lshl_b32 s52, s52, 17
    s_add_u32 s52, s52, 4194304
    v_mul_u32_u24 v248, 40960, v1
    v_add_u32 v248, s52, v248
    s_mov_b32 s54, 0x8000
    s_mov_b32 s55, 0x380000
    v_writelane_b32 v248, s54, 4
    v_writelane_b32 v248, s55, 5
    s_lshl_b32 s53, s47, 17
    v_mov_b32 v249, s53
    s_mov_b64 exec, 0x3f
    global_load_dword v252, v248, s[84:85]
    s_mov_b64 exec, 1
    global_load_dword v253, v249, s[80:81]
    s_mov_b64 exec, -1
    v_bfe_u32 v49, v1, 1, 3
    v_xor_b32 v49, v49, v48
    v_lshlrev_b32 v49, 4, v49
    v_lshl_add_u32 v49, v51, 7, v49
    v_add_u32 v6, s41, v49
    v_xor_b32 v7, 64, v6
    v_xor_b32 v8, 0x1000, v6
    v_xor_b32 v9, 0x1000, v7
    v_bfe_u32 v49, v1, 2, 2
    v_lshl_add_u32 v50, v48, 3, v49
    v_lshlrev_b32 v50, 8, v50
    v_lshl_add_u32 v50, v49, 6, v50
    v_bfe_u32 v52, v1, 4, 1
    v_lshl_add_u32 v50, v52, 5, v50
    v_and_b32 v46, 3, v1
    v_lshl_add_u32 v50, v46, 3, v50
    s_and_b32 s63, s32, 1
    s_lshl_b32 s64, s63, 7
    s_add_u32 s64, s64, 16384
    v_xor_b32 v18, s64, v50
    v_xor_b32 v19, 32, v18
    v_xor_b32 v20, 64, v18
    v_xor_b32 v21, 96, v18
    s_or_b32 s3, s2, s32
    s_cbranch_scc0 L_leader
L_noleader:
    s_waitcnt vmcnt(10)
    s_barrier
    ds_read_b64_tr_b16 a[16:17], v18 offset:0
    ds_read_b64_tr_b16 a[18:19], v18 offset:1024
    ds_read_b128 a[0:3], v6 offset:0
    ds_read_b128 a[4:7], v6 offset:2048
    ds_read_b128 a[8:11], v8 offset:0
    ds_read_b128 a[12:15], v8 offset:2048
    ds_read_b64_tr_b16 a[20:21], v19 offset:0
    ds_read_b64_tr_b16 a[22:23], v19 offset:1024
    ds_read_b64_tr_b16 a[24:25], v20 offset:0
    ds_read_b64_tr_b16 a[26:27], v20 offset:1024
    ds_read_b64_tr_b16 a[28:29], v21 offset:0
    ds_read_b64_tr_b16 a[30:31], v21 offset:1024
    s_waitcnt lgkmcnt(6)
    v_mfma_f32_16x16x32_bf16 v[64:67], a[16:19], a[0:3], 0
    ds_read_b64_tr_b16 a[48:49], v18 offset:8192
    s_and_b32 s35, s36, 15
    s_add_u32 m0, s41, 65536
    s_lshl_b32 s34, s35, 7
    v_add_u32 v14, 0x10000, v6
    v_add_u32 v15, 0x10000, v7
    v_add_u32 v16, 0x10000, v8
    v_mfma_f32_16x16x32_bf16 v[80:83], a[16:19], a[4:7], 0
    buffer_load_dwordx4 v22, s[8:11], s34 offen offset:0 lds
    v_add_u32 v17, 0x10000, v9
    v_add_u32 v136, 0x10000, v18
    v_add_u32 v137, 0x10000, v19
    v_mfma_f32_16x16x32_bf16 v[96:99], a[16:19], a[8:11], 0
    ds_read_b64_tr_b16 a[50:51], v18 offset:9216
    v_add_u32 v138, 0x10000, v20
    v_add_u32 v139, 0x10000, v21
    s_mov_b64 s[24:25], s[70:71]
    v_mfma_f32_16x16x32_bf16 v[112:115], a[16:19], a[12:15], 0
    ds_read_b128 a[32:35], v7 offset:0
    buffer_load_dwordx4 v23, s[8:11], s34 offen offset:1024 lds
    s_mov_b32 s26, 0x400000
    s_mov_b32 s27, 0x20000
    s_lshl_b32 s47, s47, 5
    s_waitcnt lgkmcnt(5)
    v_mfma_f32_16x16x32_bf16 v[116:119], a[20:23], a[12:15], 0
    ds_read_b128 a[36:39], v7 offset:2048
    s_lshr_b64 s[36:37], s[36:37], 4
    s_add_u32 s47, s47, s62
    s_lshl_b32 s4, s47, 13
    s_lshl_b32 s5, s32, 13
    v_mfma_f32_16x16x32_bf16 v[100:103], a[20:23], a[8:11], 0
    buffer_load_dwordx4 v24, s[8:11], s34 offen offset:2048 lds
    s_add_u32 s5, s5, 131072
    v_xor_b32 v46, v51, v48
    v_lshlrev_b32 v46, 4, v46
    v_mfma_f32_16x16x32_bf16 v[84:87], a[20:23], a[4:7], 0
    ds_read_b128 a[40:43], v9 offset:0
    v_lshl_add_u32 v30, v48, 8, v46
    v_xor_b32 v31, 64, v30
    v_xor_b32 v32, 128, v30
    v_mfma_f32_16x16x32_bf16 v[68:71], a[20:23], a[0:3], 0
    ds_read_b128 a[44:47], v9 offset:2048
    buffer_load_dwordx4 v25, s[8:11], s34 offen offset:3072 lds
    v_xor_b32 v33, 192, v30
    v_lshrrev_b32 v47, 5, v1
    s_lshl_b32 s63, s63, 3
    v_mfma_f32_16x16x32_bf16 v[72:75], a[24:27], a[0:3], 0
    ds_read_b64_tr_b16 a[52:53], v19 offset:8192
    s_add_u32 m0, s42, 65536
    s_lshl_b32 s35, s35, 19
    v_or_b32 v46, s63, v47
    v_xor_b32 v46, v46, v51
    v_lshlrev_b32 v46, 4, v46
    v_mfma_f32_16x16x32_bf16 v[88:91], a[24:27], a[4:7], 0
    buffer_load_dwordx4 v26, s[12:15], s35 offen offset:0 lds
    v_lshl_add_u32 v46, v51, 8, v46
    v_lshl_add_u32 v46, v52, 3, v46
    v_add_u32 v128, s5, v46
    v_mfma_f32_16x16x32_bf16 v[104:107], a[24:27], a[8:11], 0
    ds_read_b64_tr_b16 a[54:55], v19 offset:9216
    v_lshl_add_u32 v46, v52, 5, v51
    v_lshlrev_b32 v46, 4, v46
    v_lshl_add_u32 v140, v47, 3, v46
    v_mfma_f32_16x16x32_bf16 v[120:123], a[24:27], a[12:15], 0
    ds_read_b64_tr_b16 a[56:57], v20 offset:8192
    buffer_load_dwordx4 v27, s[12:15], s35 offen offset:1024 lds
    s_bfe_u32 s28, s2, 0x10002
    s_mov_b32 s3, 0
    s_waitcnt lgkmcnt(9)
    v_mfma_f32_16x16x32_bf16 v[124:127], a[28:31], a[12:15], 0
    ds_read_b64_tr_b16 a[58:59], v20 offset:9216
    v_mfma_f32_16x16x32_bf16 v[108:111], a[28:31], a[8:11], 0
    buffer_load_dwordx4 v28, s[12:15], s35 offen offset:2048 lds
    v_mfma_f32_16x16x32_bf16 v[92:95], a[28:31], a[4:7], 0
    ds_read_b64_tr_b16 a[60:61], v21 offset:8192
    v_mfma_f32_16x16x32_bf16 v[76:79], a[28:31], a[0:3], 0
    ds_read_b64_tr_b16 a[62:63], v21 offset:9216
    buffer_load_dwordx4 v29, s[12:15], s35 offen offset:3072 lds
    s_mov_b32 s43, 0
L_g1_loop:
    s_waitcnt vmcnt(8)
    s_barrier
    s_waitcnt lgkmcnt(6)
    v_mfma_f32_16x16x32_bf16 v[64:67], a[48:51], a[32:35], v[64:67]
    ds_read_b64_tr_b16 a[16:17], v18 offset:32768
    s_bitcmp1_b32 s40, 3
    s_cbranch_scc1 L_kev0
L_kev0_back:
    s_and_b32 s35, s36, 15
    s_add_u32 m0, s41, 98304
    s_lshl_b32 s34, s35, 7
    v_mfma_f32_16x16x32_bf16 v[80:83], a[48:51], a[36:39], v[80:83]
    buffer_load_dwordx4 v22, s[8:11], s34 offen offset:0 lds
    v_mfma_f32_16x16x32_bf16 v[96:99], a[48:51], a[40:43], v[96:99]
    ds_read_b64_tr_b16 a[18:19], v18 offset:33792
    v_mfma_f32_16x16x32_bf16 v[112:115], a[48:51], a[44:47], v[112:115]
    ds_read_b128 a[0:3], v6 offset:32768
    s_waitcnt lgkmcnt(5)
    v_mfma_f32_16x16x32_bf16 v[116:119], a[52:55], a[44:47], v[116:119]
    ds_read_b128 a[4:7], v6 offset:34816
    v_mfma_f32_16x16x32_bf16 v[100:103], a[52:55], a[40:43], v[100:103]
    buffer_load_dwordx4 v23, s[8:11], s34 offen offset:1024 lds
    v_mfma_f32_16x16x32_bf16 v[84:87], a[52:55], a[36:39], v[84:87]
    ds_read_b128 a[8:11], v8 offset:32768
    v_mfma_f32_16x16x32_bf16 v[68:71], a[52:55], a[32:35], v[68:71]
    ds_read_b128 a[12:15], v8 offset:34816
    v_mfma_f32_16x16x32_bf16 v[72:75], a[56:59], a[32:35], v[72:75]
    ds_read_b64_tr_b16 a[20:21], v19 offset:32768
    s_lshr_b64 s[36:37], s[36:37], 4
    v_mfma_f32_16x16x32_bf16 v[88:91], a[56:59], a[36:39], v[88:91]
    buffer_load_dwordx4 v24, s[8:11], s34 offen offset:2048 lds
    v_mfma_f32_16x16x32_bf16 v[104:107], a[56:59], a[40:43], v[104:107]
    ds_read_b64_tr_b16 a[22:23], v19 offset:33792
    v_mfma_f32_16x16x32_bf16 v[120:123], a[56:59], a[44:47], v[120:123]
    ds_read_b64_tr_b16 a[24:25], v20 offset:32768
    s_waitcnt lgkmcnt(9)
    v_mfma_f32_16x16x32_bf16 v[124:127], a[60:63], a[44:47], v[124:127]
    ds_read_b64_tr_b16 a[26:27], v20 offset:33792
    v_mfma_f32_16x16x32_bf16 v[108:111], a[60:63], a[40:43], v[108:111]
    buffer_load_dwordx4 v25, s[8:11], s34 offen offset:3072 lds
    v_mfma_f32_16x16x32_bf16 v[92:95], a[60:63], a[36:39], v[92:95]
    ds_read_b64_tr_b16 a[28:29], v21 offset:32768
    v_mfma_f32_16x16x32_bf16 v[76:79], a[60:63], a[32:35], v[76:79]
    ds_read_b64_tr_b16 a[30:31], v21 offset:33792
    s_waitcnt lgkmcnt(6)
    v_mfma_f32_16x16x32_bf16 v[64:67], a[16:19], a[0:3], v[64:67]
    ds_read_b64_tr_b16 a[48:49], v18 offset:40960
    s_add_u32 m0, s42, 98304
    s_lshl_b32 s35, s35, 19
    v_mfma_f32_16x16x32_bf16 v[80:83], a[16:19], a[4:7], v[80:83]
    buffer_load_dwordx4 v26, s[12:15], s35 offen offset:0 lds
    v_mfma_f32_16x16x32_bf16 v[96:99], a[16:19], a[8:11], v[96:99]
    ds_read_b64_tr_b16 a[50:51], v18 offset:41984
    v_mfma_f32_16x16x32_bf16 v[112:115], a[16:19], a[12:15], v[112:115]
    ds_read_b128 a[32:35], v7 offset:32768
    s_waitcnt lgkmcnt(5)
    v_mfma_f32_16x16x32_bf16 v[116:119], a[20:23], a[12:15], v[116:119]
    ds_read_b128 a[36:39], v7 offset:34816
    v_mfma_f32_16x16x32_bf16 v[100:103], a[20:23], a[8:11], v[100:103]
    buffer_load_dwordx4 v27, s[12:15], s35 offen offset:1024 lds
    v_mfma_f32_16x16x32_bf16 v[84:87], a[20:23], a[4:7], v[84:87]
    ds_read_b128 a[40:43], v9 offset:32768
    v_mfma_f32_16x16x32_bf16 v[68:71], a[20:23], a[0:3], v[68:71]
    ds_read_b128 a[44:47], v9 offset:34816
    v_mfma_f32_16x16x32_bf16 v[72:75], a[24:27], a[0:3], v[72:75]
    ds_read_b64_tr_b16 a[52:53], v19 offset:40960
    v_mfma_f32_16x16x32_bf16 v[88:91], a[24:27], a[4:7], v[88:91]
    buffer_load_dwordx4 v28, s[12:15], s35 offen offset:2048 lds
    v_mfma_f32_16x16x32_bf16 v[104:107], a[24:27], a[8:11], v[104:107]
    ds_read_b64_tr_b16 a[54:55], v19 offset:41984
    v_mfma_f32_16x16x32_bf16 v[120:123], a[24:27], a[12:15], v[120:123]
    ds_read_b64_tr_b16 a[56:57], v20 offset:40960
    s_waitcnt lgkmcnt(9)
    v_mfma_f32_16x16x32_bf16 v[124:127], a[28:31], a[12:15], v[124:127]
    ds_read_b64_tr_b16 a[58:59], v20 offset:41984
    v_mfma_f32_16x16x32_bf16 v[108:111], a[28:31], a[8:11], v[108:111]
    buffer_load_dwordx4 v29, s[12:15], s35 offen offset:3072 lds
    v_mfma_f32_16x16x32_bf16 v[92:95], a[28:31], a[4:7], v[92:95]
    ds_read_b64_tr_b16 a[60:61], v21 offset:40960
    v_mfma_f32_16x16x32_bf16 v[76:79], a[28:31], a[0:3], v[76:79]
    ds_read_b64_tr_b16 a[62:63], v21 offset:41984
    s_waitcnt vmcnt(8)
    s_barrier
    s_waitcnt lgkmcnt(6)
    v_mfma_f32_16x16x32_bf16 v[64:67], a[48:51], a[32:35], v[64:67]
    ds_read_b64_tr_b16 a[16:17], v136 offset:0
    s_bitcmp1_b32 s40, 4
    s_cbranch_scc1 L_kev1
L_kev1_back:
    s_and_b32 s35, s36, 15
    s_add_u32 m0, s41, 0
    s_lshl_b32 s34, s35, 7
    v_mfma_f32_16x16x32_bf16 v[80:83], a[48:51], a[36:39], v[80:83]
    buffer_load_dwordx4 v22, s[8:11], s34 offen offset:0 lds
    v_mfma_f32_16x16x32_bf16 v[96:99], a[48:51], a[40:43], v[96:99]
    ds_read_b64_tr_b16 a[18:19], v136 offset:1024
    v_mfma_f32_16x16x32_bf16 v[112:115], a[48:51], a[44:47], v[112:115]
    ds_read_b128 a[0:3], v14 offset:0
    s_waitcnt lgkmcnt(5)
    v_mfma_f32_16x16x32_bf16 v[116:119], a[52:55], a[44:47], v[116:119]
    ds_read_b128 a[4:7], v14 offset:2048
    v_mfma_f32_16x16x32_bf16 v[100:103], a[52:55], a[40:43], v[100:103]
    buffer_load_dwordx4 v23, s[8:11], s34 offen offset:1024 lds
    v_mfma_f32_16x16x32_bf16 v[84:87], a[52:55], a[36:39], v[84:87]
    ds_read_b128 a[8:11], v16 offset:0
    v_mfma_f32_16x16x32_bf16 v[68:71], a[52:55], a[32:35], v[68:71]
    ds_read_b128 a[12:15], v16 offset:2048
    v_mfma_f32_16x16x32_bf16 v[72:75], a[56:59], a[32:35], v[72:75]
    ds_read_b64_tr_b16 a[20:21], v137 offset:0
    s_lshr_b64 s[36:37], s[36:37], 4
    v_mfma_f32_16x16x32_bf16 v[88:91], a[56:59], a[36:39], v[88:91]
    buffer_load_dwordx4 v24, s[8:11], s34 offen offset:2048 lds
    v_mfma_f32_16x16x32_bf16 v[104:107], a[56:59], a[40:43], v[104:107]
    ds_read_b64_tr_b16 a[22:23], v137 offset:1024
    v_mfma_f32_16x16x32_bf16 v[120:123], a[56:59], a[44:47], v[120:123]
    ds_read_b64_tr_b16 a[24:25], v138 offset:0
    s_waitcnt lgkmcnt(9)
    v_mfma_f32_16x16x32_bf16 v[124:127], a[60:63], a[44:47], v[124:127]
    ds_read_b64_tr_b16 a[26:27], v138 offset:1024
    v_mfma_f32_16x16x32_bf16 v[108:111], a[60:63], a[40:43], v[108:111]
    buffer_load_dwordx4 v25, s[8:11], s34 offen offset:3072 lds
    v_mfma_f32_16x16x32_bf16 v[92:95], a[60:63], a[36:39], v[92:95]
    ds_read_b64_tr_b16 a[28:29], v139 offset:0
    v_mfma_f32_16x16x32_bf16 v[76:79], a[60:63], a[32:35], v[76:79]
    ds_read_b64_tr_b16 a[30:31], v139 offset:1024
    s_waitcnt lgkmcnt(6)
    v_mfma_f32_16x16x32_bf16 v[64:67], a[16:19], a[0:3], v[64:67]
    ds_read_b64_tr_b16 a[48:49], v136 offset:8192
    s_add_u32 m0, s42, 0
    s_lshl_b32 s35, s35, 19
    v_mfma_f32_16x16x32_bf16 v[80:83], a[16:19], a[4:7], v[80:83]
    buffer_load_dwordx4 v26, s[12:15], s35 offen offset:0 lds
    v_mfma_f32_16x16x32_bf16 v[96:99], a[16:19], a[8:11], v[96:99]
    ds_read_b64_tr_b16 a[50:51], v136 offset:9216
    v_mfma_f32_16x16x32_bf16 v[112:115], a[16:19], a[12:15], v[112:115]
    ds_read_b128 a[32:35], v15 offset:0
    s_waitcnt lgkmcnt(5)
    v_mfma_f32_16x16x32_bf16 v[116:119], a[20:23], a[12:15], v[116:119]
    ds_read_b128 a[36:39], v15 offset:2048
    v_mfma_f32_16x16x32_bf16 v[100:103], a[20:23], a[8:11], v[100:103]
    buffer_load_dwordx4 v27, s[12:15], s35 offen offset:1024 lds
    v_mfma_f32_16x16x32_bf16 v[84:87], a[20:23], a[4:7], v[84:87]
    ds_read_b128 a[40:43], v17 offset:0
    v_mfma_f32_16x16x32_bf16 v[68:71], a[20:23], a[0:3], v[68:71]
    ds_read_b128 a[44:47], v17 offset:2048
    v_mfma_f32_16x16x32_bf16 v[72:75], a[24:27], a[0:3], v[72:75]
    ds_read_b64_tr_b16 a[52:53], v137 offset:8192
    v_mfma_f32_16x16x32_bf16 v[88:91], a[24:27], a[4:7], v[88:91]
    buffer_load_dwordx4 v28, s[12:15], s35 offen offset:2048 lds
    v_mfma_f32_16x16x32_bf16 v[104:107], a[24:27], a[8:11], v[104:107]
    ds_read_b64_tr_b16 a[54:55], v137 offset:9216
    v_mfma_f32_16x16x32_bf16 v[120:123], a[24:27], a[12:15], v[120:123]
    ds_read_b64_tr_b16 a[56:57], v138 offset:8192
    s_waitcnt lgkmcnt(9)
    v_mfma_f32_16x16x32_bf16 v[124:127], a[28:31], a[12:15], v[124:127]
    ds_read_b64_tr_b16 a[58:59], v138 offset:9216
    v_mfma_f32_16x16x32_bf16 v[108:111], a[28:31], a[8:11], v[108:111]
    buffer_load_dwordx4 v29, s[12:15], s35 offen offset:3072 lds
    v_mfma_f32_16x16x32_bf16 v[92:95], a[28:31], a[4:7], v[92:95]
    ds_read_b64_tr_b16 a[60:61], v139 offset:8192
    v_mfma_f32_16x16x32_bf16 v[76:79], a[28:31], a[0:3], v[76:79]
    ds_read_b64_tr_b16 a[62:63], v139 offset:9216
    s_waitcnt vmcnt(8)
    s_barrier
    s_waitcnt lgkmcnt(6)
    v_mfma_f32_16x16x32_bf16 v[64:67], a[48:51], a[32:35], v[64:67]
    ds_read_b64_tr_b16 a[16:17], v136 offset:32768
    s_bitcmp1_b32 s40, 5
    s_cbranch_scc1 L_kev2
L_kev2_back:
    s_and_b32 s35, s36, 15
    s_add_u32 m0, s41, 32768
    s_lshl_b32 s34, s35, 7
    v_mfma_f32_16x16x32_bf16 v[80:83], a[48:51], a[36:39], v[80:83]
    buffer_load_dwordx4 v22, s[8:11], s34 offen offset:0 lds
    v_mfma_f32_16x16x32_bf16 v[96:99], a[48:51], a[40:43], v[96:99]
    ds_read_b64_tr_b16 a[18:19], v136 offset:33792
    v_mfma_f32_16x16x32_bf16 v[112:115], a[48:51], a[44:47], v[112:115]
    ds_read_b128 a[0:3], v14 offset:32768
    s_waitcnt lgkmcnt(5)
    v_mfma_f32_16x16x32_bf16 v[116:119], a[52:55], a[44:47], v[116:119]
    ds_read_b128 a[4:7], v14 offset:34816
    v_mfma_f32_16x16x32_bf16 v[100:103], a[52:55], a[40:43], v[100:103]
    buffer_load_dwordx4 v23, s[8:11], s34 offen offset:1024 lds
    v_mfma_f32_16x16x32_bf16 v[84:87], a[52:55], a[36:39], v[84:87]
    ds_read_b128 a[8:11], v16 offset:32768
    v_mfma_f32_16x16x32_bf16 v[68:71], a[52:55], a[32:35], v[68:71]
    ds_read_b128 a[12:15], v16 offset:34816
    v_mfma_f32_16x16x32_bf16 v[72:75], a[56:59], a[32:35], v[72:75]
    ds_read_b64_tr_b16 a[20:21], v137 offset:32768
    s_lshr_b64 s[36:37], s[36:37], 4
    v_mfma_f32_16x16x32_bf16 v[88:91], a[56:59], a[36:39], v[88:91]
    buffer_load_dwordx4 v24, s[8:11], s34 offen offset:2048 lds
    v_mfma_f32_16x16x32_bf16 v[104:107], a[56:59], a[40:43], v[104:107]
    ds_read_b64_tr_b16 a[22:23], v137 offset:33792
    v_mfma_f32_16x16x32_bf16 v[120:123], a[56:59], a[44:47], v[120:123]
    ds_read_b64_tr_b16 a[24:25], v138 offset:32768
    s_waitcnt lgkmcnt(9)
    v_mfma_f32_16x16x32_bf16 v[124:127], a[60:63], a[44:47], v[124:127]
    ds_read_b64_tr_b16 a[26:27], v138 offset:33792
    v_mfma_f32_16x16x32_bf16 v[108:111], a[60:63], a[40:43], v[108:111]
    buffer_load_dwordx4 v25, s[8:11], s34 offen offset:3072 lds
    v_mfma_f32_16x16x32_bf16 v[92:95], a[60:63], a[36:39], v[92:95]
    ds_read_b64_tr_b16 a[28:29], v139 offset:32768
    v_mfma_f32_16x16x32_bf16 v[76:79], a[60:63], a[32:35], v[76:79]
    ds_read_b64_tr_b16 a[30:31], v139 offset:33792
    s_waitcnt lgkmcnt(6)
    v_mfma_f32_16x16x32_bf16 v[64:67], a[16:19], a[0:3], v[64:67]
    ds_read_b64_tr_b16 a[48:49], v136 offset:40960
    s_add_u32 m0, s42, 32768
    s_lshl_b32 s35, s35, 19
    v_mfma_f32_16x16x32_bf16 v[80:83], a[16:19], a[4:7], v[80:83]
    buffer_load_dwordx4 v26, s[12:15], s35 offen offset:0 lds
    v_mfma_f32_16x16x32_bf16 v[96:99], a[16:19], a[8:11], v[96:99]
    ds_read_b64_tr_b16 a[50:51], v136 offset:41984
    v_mfma_f32_16x16x32_bf16 v[112:115], a[16:19], a[12:15], v[112:115]
    ds_read_b128 a[32:35], v15 offset:32768
    s_waitcnt lgkmcnt(5)
    v_mfma_f32_16x16x32_bf16 v[116:119], a[20:23], a[12:15], v[116:119]
    ds_read_b128 a[36:39], v15 offset:34816
    v_mfma_f32_16x16x32_bf16 v[100:103], a[20:23], a[8:11], v[100:103]
    buffer_load_dwordx4 v27, s[12:15], s35 offen offset:1024 lds
    v_mfma_f32_16x16x32_bf16 v[84:87], a[20:23], a[4:7], v[84:87]
    ds_read_b128 a[40:43], v17 offset:32768
    v_mfma_f32_16x16x32_bf16 v[68:71], a[20:23], a[0:3], v[68:71]
    ds_read_b128 a[44:47], v17 offset:34816
    v_mfma_f32_16x16x32_bf16 v[72:75], a[24:27], a[0:3], v[72:75]
    ds_read_b64_tr_b16 a[52:53], v137 offset:40960
    v_mfma_f32_16x16x32_bf16 v[88:91], a[24:27], a[4:7], v[88:91]
    buffer_load_dwordx4 v28, s[12:15], s35 offen offset:2048 lds
    v_mfma_f32_16x16x32_bf16 v[104:107], a[24:27], a[8:11], v[104:107]
    ds_read_b64_tr_b16 a[54:55], v137 offset:41984
    v_mfma_f32_16x16x32_bf16 v[120:123], a[24:27], a[12:15], v[120:123]
    ds_read_b64_tr_b16 a[56:57], v138 offset:40960
    s_waitcnt lgkmcnt(9)
    v_mfma_f32_16x16x32_bf16 v[124:127], a[28:31], a[12:15], v[124:127]
    ds_read_b64_tr_b16 a[58:59], v138 offset:41984
    v_mfma_f32_16x16x32_bf16 v[108:111], a[28:31], a[8:11], v[108:111]
    buffer_load_dwordx4 v29, s[12:15], s35 offen offset:3072 lds
    v_mfma_f32_16x16x32_bf16 v[92:95], a[28:31], a[4:7], v[92:95]
    ds_read_b64_tr_b16 a[60:61], v139 offset:40960
    v_mfma_f32_16x16x32_bf16 v[76:79], a[28:31], a[0:3], v[76:79]
    ds_read_b64_tr_b16 a[62:63], v139 offset:41984
    s_waitcnt vmcnt(8)
    s_barrier
    s_waitcnt lgkmcnt(6)
    v_mfma_f32_16x16x32_bf16 v[64:67], a[48:51], a[32:35], v[64:67]
    ds_read_b64_tr_b16 a[16:17], v18 offset:0
    s_bitcmp1_b32 s40, 6
    s_cbranch_scc1 L_kev3
L_kev3_back:
    s_and_b32 s35, s36, 15
    s_add_u32 m0, s41, 65536
    s_lshl_b32 s34, s35, 7
    v_mfma_f32_16x16x32_bf16 v[80:83], a[48:51], a[36:39], v[80:83]
    buffer_load_dwordx4 v22, s[8:11], s34 offen offset:0 lds
    v_mfma_f32_16x16x32_bf16 v[96:99], a[48:51], a[40:43], v[96:99]
    ds_read_b64_tr_b16 a[18:19], v18 offset:1024
    v_mfma_f32_16x16x32_bf16 v[112:115], a[48:51], a[44:47], v[112:115]
    ds_read_b128 a[0:3], v6 offset:0
    s_waitcnt lgkmcnt(5)
    v_mfma_f32_16x16x32_bf16 v[116:119], a[52:55], a[44:47], v[116:119]
    ds_read_b128 a[4:7], v6 offset:2048
    v_mfma_f32_16x16x32_bf16 v[100:103], a[52:55], a[40:43], v[100:103]
    buffer_load_dwordx4 v23, s[8:11], s34 offen offset:1024 lds
    v_mfma_f32_16x16x32_bf16 v[84:87], a[52:55], a[36:39], v[84:87]
    ds_read_b128 a[8:11], v8 offset:0
    v_mfma_f32_16x16x32_bf16 v[68:71], a[52:55], a[32:35], v[68:71]
    ds_read_b128 a[12:15], v8 offset:2048
    v_mfma_f32_16x16x32_bf16 v[72:75], a[56:59], a[32:35], v[72:75]
    ds_read_b64_tr_b16 a[20:21], v19 offset:0
    s_lshr_b64 s[36:37], s[36:37], 4
    v_mfma_f32_16x16x32_bf16 v[88:91], a[56:59], a[36:39], v[88:91]
    buffer_load_dwordx4 v24, s[8:11], s34 offen offset:2048 lds
    v_mfma_f32_16x16x32_bf16 v[104:107], a[56:59], a[40:43], v[104:107]
    ds_read_b64_tr_b16 a[22:23], v19 offset:1024
    v_mfma_f32_16x16x32_bf16 v[120:123], a[56:59], a[44:47], v[120:123]
    ds_read_b64_tr_b16 a[24:25], v20 offset:0
    s_waitcnt lgkmcnt(9)
    v_mfma_f32_16x16x32_bf16 v[124:127], a[60:63], a[44:47], v[124:127]
    ds_read_b64_tr_b16 a[26:27], v20 offset:1024
    v_mfma_f32_16x16x32_bf16 v[108:111], a[60:63], a[40:43], v[108:111]
    buffer_load_dwordx4 v25, s[8:11], s34 offen offset:3072 lds
    v_mfma_f32_16x16x32_bf16 v[92:95], a[60:63], a[36:39], v[92:95]
    ds_read_b64_tr_b16 a[28:29], v21 offset:0
    v_mfma_f32_16x16x32_bf16 v[76:79], a[60:63], a[32:35], v[76:79]
    ds_read_b64_tr_b16 a[30:31], v21 offset:1024
    s_waitcnt lgkmcnt(6)
    v_mfma_f32_16x16x32_bf16 v[64:67], a[16:19], a[0:3], v[64:67]
    ds_read_b64_tr_b16 a[48:49], v18 offset:8192
    s_add_u32 m0, s42, 65536
    s_lshl_b32 s35, s35, 19
    v_mfma_f32_16x16x32_bf16 v[80:83], a[16:19], a[4:7], v[80:83]
    buffer_load_dwordx4 v26, s[12:15], s35 offen offset:0 lds
    v_mfma_f32_16x16x32_bf16 v[96:99], a[16:19], a[8:11], v[96:99]
    ds_read_b64_tr_b16 a[50:51], v18 offset:9216
    v_mfma_f32_16x16x32_bf16 v[112:115], a[16:19], a[12:15], v[112:115]
    ds_read_b128 a[32:35], v7 offset:0
    s_waitcnt lgkmcnt(5)
    v_mfma_f32_16x16x32_bf16 v[116:119], a[20:23], a[12:15], v[116:119]
    ds_read_b128 a[36:39], v7 offset:2048
    v_mfma_f32_16x16x32_bf16 v[100:103], a[20:23], a[8:11], v[100:103]
    buffer_load_dwordx4 v27, s[12:15], s35 offen offset:1024 lds
    v_mfma_f32_16x16x32_bf16 v[84:87], a[20:23], a[4:7], v[84:87]
    ds_read_b128 a[40:43], v9 offset:0
    v_mfma_f32_16x16x32_bf16 v[68:71], a[20:23], a[0:3], v[68:71]
    ds_read_b128 a[44:47], v9 offset:2048
    v_mfma_f32_16x16x32_bf16 v[72:75], a[24:27], a[0:3], v[72:75]
    ds_read_b64_tr_b16 a[52:53], v19 offset:8192
    v_mfma_f32_16x16x32_bf16 v[88:91], a[24:27], a[4:7], v[88:91]
    buffer_load_dwordx4 v28, s[12:15], s35 offen offset:2048 lds
    v_mfma_f32_16x16x32_bf16 v[104:107], a[24:27], a[8:11], v[104:107]
    ds_read_b64_tr_b16 a[54:55], v19 offset:9216
    v_mfma_f32_16x16x32_bf16 v[120:123], a[24:27], a[12:15], v[120:123]
    ds_read_b64_tr_b16 a[56:57], v20 offset:8192
    s_waitcnt lgkmcnt(9)
    v_mfma_f32_16x16x32_bf16 v[124:127], a[28:31], a[12:15], v[124:127]
    ds_read_b64_tr_b16 a[58:59], v20 offset:9216
    v_mfma_f32_16x16x32_bf16 v[108:111], a[28:31], a[8:11], v[108:111]
    buffer_load_dwordx4 v29, s[12:15], s35 offen offset:3072 lds
    v_mfma_f32_16x16x32_bf16 v[92:95], a[28:31], a[4:7], v[92:95]
    ds_read_b64_tr_b16 a[60:61], v21 offset:8192
    v_mfma_f32_16x16x32_bf16 v[76:79], a[28:31], a[0:3], v[76:79]
    ds_read_b64_tr_b16 a[62:63], v21 offset:9216
    s_lshr_b32 s40, s40, 4
    s_add_u32 s43, s43, 1
    s_cmp_lt_u32 s43, 3
    s_cbranch_scc1 L_g1_loop
    s_waitcnt vmcnt(8)
    s_barrier
    s_waitcnt lgkmcnt(6)
    v_mfma_f32_16x16x32_bf16 v[64:67], a[48:51], a[32:35], v[64:67]
    ds_read_b64_tr_b16 a[16:17], v18 offset:32768
    s_and_b32 s35, s36, 15
    s_add_u32 m0, s41, 98304
    s_lshl_b32 s34, s35, 7
    s_lshr_b32 s61, s47, 5
    s_lshl_b32 s61, s61, 18
    v_mfma_f32_16x16x32_bf16 v[80:83], a[48:51], a[36:39], v[80:83]
    buffer_load_dwordx4 v22, s[8:11], s34 offen offset:0 lds
    s_lshl_b32 s64, s29, 16
    s_add_u32 s61, s61, s64
    v_mfma_f32_16x16x32_bf16 v[96:99], a[48:51], a[40:43], v[96:99]
    ds_read_b64_tr_b16 a[18:19], v18 offset:33792
    v_add_u32 v34, s61, v34
    v_xor_b32 v35, 64, v34
    v_mfma_f32_16x16x32_bf16 v[112:115], a[48:51], a[44:47], v[112:115]
    ds_read_b128 a[0:3], v6 offset:32768
    v_add_u32 v36, 2048, v34
    v_add_u32 v37, 3072, v35
    s_waitcnt lgkmcnt(5)
    v_mfma_f32_16x16x32_bf16 v[116:119], a[52:55], a[44:47], v[116:119]
    ds_read_b128 a[4:7], v6 offset:34816
    v_add_u32 v35, 1024, v35
    s_xor_b32 s33, s31, 1
    v_mfma_f32_16x16x32_bf16 v[100:103], a[52:55], a[40:43], v[100:103]
    buffer_load_dwordx4 v23, s[8:11], s34 offen offset:1024 lds
    s_lshl_b32 s46, s33, 8
    s_lshl_b32 s64, s29, 21
    v_mfma_f32_16x16x32_bf16 v[84:87], a[52:55], a[36:39], v[84:87]
    ds_read_b128 a[8:11], v8 offset:32768
    s_add_u32 s46, s46, s64
    s_mul_i32 s64, s32, 192
    v_mfma_f32_16x16x32_bf16 v[68:71], a[52:55], a[32:35], v[68:71]
    ds_read_b128 a[12:15], v8 offset:34816
    s_mov_b32 s65, 43691
    v_add_u32 v46, s64, v1
    v_mfma_f32_16x16x32_bf16 v[72:75], a[56:59], a[32:35], v[72:75]
    ds_read_b64_tr_b16 a[20:21], v19 offset:32768
    s_lshr_b64 s[36:37], s[36:37], 4
    v_mul_u32_u24 v47, s65, v46
    v_lshrrev_b32 v47, 19, v47
    v_mfma_f32_16x16x32_bf16 v[88:91], a[56:59], a[36:39], v[88:91]
    buffer_load_dwordx4 v24, s[8:11], s34 offen offset:2048 lds
    v_mul_u32_u24 v48, 12, v47
    v_sub_u32 v46, v46, v48
    v_mfma_f32_16x16x32_bf16 v[104:107], a[56:59], a[40:43], v[104:107]
    ds_read_b64_tr_b16 a[22:23], v19 offset:33792
    v_lshrrev_b32 v48, 2, v46
    v_add_u32 v48, 1, v48
    v_mfma_f32_16x16x32_bf16 v[120:123], a[56:59], a[44:47], v[120:123]
    ds_read_b64_tr_b16 a[24:25], v20 offset:32768
    v_xor_b32 v48, s29, v48
    v_and_b32 v46, 3, v46
    s_waitcnt lgkmcnt(9)
    v_mfma_f32_16x16x32_bf16 v[124:127], a[60:63], a[44:47], v[124:127]
    ds_read_b64_tr_b16 a[26:27], v20 offset:33792
    v_lshlrev_b32 v46, 4, v46
    v_lshl_add_u32 v46, v48, 6, v46
    v_mfma_f32_16x16x32_bf16 v[108:111], a[60:63], a[40:43], v[108:111]
    buffer_load_dwordx4 v25, s[8:11], s34 offen offset:3072 lds
    v_lshl_add_u32 v46, v47, 11, v46
    s_sub_u32 s63, s46, 0
    v_mfma_f32_16x16x32_bf16 v[92:95], a[60:63], a[36:39], v[92:95]
    ds_read_b64_tr_b16 a[28:29], v21 offset:32768
    v_add_u32 v38, s63, v46
    s_add_u32 s64, s64, 64
    v_mfma_f32_16x16x32_bf16 v[76:79], a[60:63], a[32:35], v[76:79]
    ds_read_b64_tr_b16 a[30:31], v21 offset:33792
    v_add_u32 v46, s64, v1
    v_mul_u32_u24 v47, s65, v46
    s_waitcnt lgkmcnt(6)
    v_mfma_f32_16x16x32_bf16 v[64:67], a[16:19], a[0:3], v[64:67]
    ds_read_b64_tr_b16 a[48:49], v18 offset:40960
    s_add_u32 m0, s42, 98304
    s_lshl_b32 s35, s35, 19
    v_lshrrev_b32 v47, 19, v47
    v_mul_u32_u24 v48, 12, v47
    v_mfma_f32_16x16x32_bf16 v[80:83], a[16:19], a[4:7], v[80:83]
    buffer_load_dwordx4 v26, s[12:15], s35 offen offset:0 lds
    v_sub_u32 v46, v46, v48
    v_lshrrev_b32 v48, 2, v46
    v_mfma_f32_16x16x32_bf16 v[96:99], a[16:19], a[8:11], v[96:99]
    ds_read_b64_tr_b16 a[50:51], v18 offset:41984
    v_add_u32 v48, 1, v48
    v_xor_b32 v48, s29, v48
    v_mfma_f32_16x16x32_bf16 v[112:115], a[16:19], a[12:15], v[112:115]
    ds_read_b128 a[32:35], v7 offset:32768
    v_and_b32 v46, 3, v46
    v_lshlrev_b32 v46, 4, v46
    s_waitcnt lgkmcnt(5)
    v_mfma_f32_16x16x32_bf16 v[116:119], a[20:23], a[12:15], v[116:119]
    ds_read_b128 a[36:39], v7 offset:34816
    v_lshl_add_u32 v46, v48, 6, v46
    v_lshl_add_u32 v46, v47, 11, v46
    v_mfma_f32_16x16x32_bf16 v[100:103], a[20:23], a[8:11], v[100:103]
    buffer_load_dwordx4 v27, s[12:15], s35 offen offset:1024 lds
    s_sub_u32 s63, s46, 1024
    v_add_u32 v39, s63, v46
    v_mfma_f32_16x16x32_bf16 v[84:87], a[20:23], a[4:7], v[84:87]
    ds_read_b128 a[40:43], v9 offset:32768
    s_add_u32 s64, s64, 64
    v_add_u32 v46, s64, v1
    v_mfma_f32_16x16x32_bf16 v[68:71], a[20:23], a[0:3], v[68:71]
    ds_read_b128 a[44:47], v9 offset:34816
    v_mul_u32_u24 v47, s65, v46
    v_lshrrev_b32 v47, 19, v47
    v_mfma_f32_16x16x32_bf16 v[72:75], a[24:27], a[0:3], v[72:75]
    ds_read_b64_tr_b16 a[52:53], v19 offset:40960
    v_mul_u32_u24 v48, 12, v47
    v_sub_u32 v46, v46, v48
    v_mfma_f32_16x16x32_bf16 v[88:91], a[24:27], a[4:7], v[88:91]
    buffer_load_dwordx4 v28, s[12:15], s35 offen offset:2048 lds
    v_lshrrev_b32 v48, 2, v46
    v_add_u32 v48, 1, v48
    v_mfma_f32_16x16x32_bf16 v[104:107], a[24:27], a[8:11], v[104:107]
    ds_read_b64_tr_b16 a[54:55], v19 offset:41984
    v_xor_b32 v48, s29, v48
    v_and_b32 v46, 3, v46
    v_mfma_f32_16x16x32_bf16 v[120:123], a[24:27], a[12:15], v[120:123]
    ds_read_b64_tr_b16 a[56:57], v20 offset:40960
    v_lshlrev_b32 v46, 4, v46
    v_lshl_add_u32 v46, v48, 6, v46
    s_waitcnt lgkmcnt(9)
    v_mfma_f32_16x16x32_bf16 v[124:127], a[28:31], a[12:15], v[124:127]
    ds_read_b64_tr_b16 a[58:59], v20 offset:41984
    v_lshl_add_u32 v46, v47, 11, v46
    s_sub_u32 s63, s46, 2048
    v_mfma_f32_16x16x32_bf16 v[108:111], a[28:31], a[8:11], v[108:111]
    buffer_load_dwordx4 v29, s[12:15], s35 offen offset:3072 lds
    v_add_u32 v57, s63, v46
    s_add_u32 s64, s64, 64
    v_mfma_f32_16x16x32_bf16 v[92:95], a[28:31], a[4:7], v[92:95]
    ds_read_b64_tr_b16 a[60:61], v21 offset:40960
    v_mfma_f32_16x16x32_bf16 v[76:79], a[28:31], a[0:3], v[76:79]
    ds_read_b64_tr_b16 a[62:63], v21 offset:41984
    s_mov_b32 s8, s72
    s_mov_b32 s9, s73
    s_mov_b32 s10, 0x400000
    s_mov_b64 s[36:37], s[6:7]
    s_mov_b64 s[4:5], s[6:7]
    s_movk_i32 s39, 7936
    s_mov_b32 s12, s76
    s_mov_b32 s13, s77
    s_mov_b32 s38, 17
    s_mul_i32 s42, s32, 3072
    s_add_u32 s42, s42, 16384
    v_mov_b32 v49, 0
    v_mov_b32 v22, v34
    v_mov_b32 v23, v35
    v_mov_b32 v24, v36
    v_mov_b32 v25, v37
    s_waitcnt vmcnt(8)
    s_barrier
    s_waitcnt lgkmcnt(6)
    v_mfma_f32_16x16x32_bf16 v[64:67], a[48:51], a[32:35], v[64:67]
    ds_read_b64_tr_b16 a[16:17], v136 offset:0
    v_and_b32 v46, 31, v1
    v_lshrrev_b32 v47, 5, v1
    v_mfma_f32_16x16x32_bf16 v[80:83], a[48:51], a[36:39], v[80:83]
    global_load_dword v45, v49, s[82:83] sc1
    v_bfe_u32 v48, v1, 1, 3
    v_xor_b32 v48, v48, v47
    v_mfma_f32_16x16x32_bf16 v[96:99], a[48:51], a[40:43], v[96:99]
    ds_read_b64_tr_b16 a[18:19], v136 offset:1024
    v_lshlrev_b32 v48, 4, v48
    v_lshl_add_u32 v48, v46, 7, v48
    v_mfma_f32_16x16x32_bf16 v[112:115], a[48:51], a[44:47], v[112:115]
    ds_read_b128 a[0:3], v14 offset:0
    v_add_u32 v2, s41, v48
    v_xor_b32 v3, 32, v2
    s_waitcnt lgkmcnt(5)
    v_mfma_f32_16x16x32_bf16 v[116:119], a[52:55], a[44:47], v[116:119]
    ds_read_b128 a[4:7], v14 offset:2048
    s_and_b32 s35, s36, 15
    s_lshr_b64 s[36:37], s[36:37], 4
    s_lshr_b32 s67, s35, 1
    s_lshl_b32 s34, s35, 7
    s_mul_i32 s67, s67, s39
    s_lshl_b32 s35, s35, s38
    s_add_u32 s34, s34, s67
    s_add_u32 m0, s41, 0
    v_xor_b32 v4, 64, v2
    v_xor_b32 v5, 96, v2
    v_mfma_f32_16x16x32_bf16 v[100:103], a[52:55], a[40:43], v[100:103]
    buffer_load_dwordx4 v22, s[8:11], s34 offen offset:0 lds
    v_bfe_u32 v46, v1, 4, 1
    v_lshlrev_b32 v46, 5, v46
    v_mfma_f32_16x16x32_bf16 v[84:87], a[52:55], a[36:39], v[84:87]
    ds_read_b128 a[8:11], v16 offset:0
    v_and_b32 v48, 1, v1
    v_lshl_add_u32 v46, v48, 4, v46
    v_mfma_f32_16x16x32_bf16 v[68:71], a[52:55], a[32:35], v[68:71]
    ds_read_b128 a[12:15], v16 offset:2048
    v_bfe_u32 v48, v1, 1, 1
    v_lshl_add_u32 v46, v48, 3, v46
    v_mfma_f32_16x16x32_bf16 v[72:75], a[56:59], a[32:35], v[72:75]
    ds_read_b64_tr_b16 a[20:21], v137 offset:0
    v_bfe_u32 v48, v1, 2, 2
    v_lshl_add_u32 v48, v47, 3, v48
    v_mfma_f32_16x16x32_bf16 v[88:91], a[56:59], a[36:39], v[88:91]
    buffer_load_dwordx4 v23, s[8:11], s34 offen offset:1024 lds
    v_mul_u32_u24 v48, 192, v48
    v_add_u32 v48, v48, v46
    v_mfma_f32_16x16x32_bf16 v[104:107], a[56:59], a[40:43], v[104:107]
    ds_read_b64_tr_b16 a[22:23], v137 offset:1024
    v_add_u32 v56, 16384, v48
    v_add_u32 v10, 65536, v2
    v_mfma_f32_16x16x32_bf16 v[120:123], a[56:59], a[44:47], v[120:123]
    ds_read_b64_tr_b16 a[24:25], v138 offset:0
    v_add_u32 v11, 65536, v3
    v_add_u32 v12, 65536, v4
    s_waitcnt lgkmcnt(9)
    v_mfma_f32_16x16x32_bf16 v[124:127], a[60:63], a[44:47], v[124:127]
    ds_read_b64_tr_b16 a[26:27], v138 offset:1024
    v_add_u32 v13, 65536, v5
    v_add_u32 v40, 131072, v2
    v_mfma_f32_16x16x32_bf16 v[108:111], a[60:63], a[40:43], v[108:111]
    buffer_load_dwordx4 v24, s[8:11], s34 offen offset:2048 lds
    v_add_u32 v41, 131072, v3
    v_add_u32 v42, 131072, v4
    v_mfma_f32_16x16x32_bf16 v[92:95], a[60:63], a[36:39], v[92:95]
    ds_read_b64_tr_b16 a[28:29], v139 offset:0
    v_add_u32 v43, 131072, v5
    v_xor_b32 v129, 32, v128
    v_mfma_f32_16x16x32_bf16 v[76:79], a[60:63], a[32:35], v[76:79]
    ds_read_b64_tr_b16 a[30:31], v139 offset:1024
    v_xor_b32 v130, 64, v128
    v_xor_b32 v131, 96, v128
    s_waitcnt lgkmcnt(6)
    v_mfma_f32_16x16x32_bf16 v[64:67], a[16:19], a[0:3], v[64:67]
    ds_read_b64_tr_b16 a[48:49], v136 offset:8192
    v_xor_b32 v132, 0x2000, v128
    v_xor_b32 v133, 0x2000, v129
    v_mfma_f32_16x16x32_bf16 v[80:83], a[16:19], a[4:7], v[80:83]
    buffer_load_dwordx4 v25, s[8:11], s34 offen offset:3072 lds
    v_xor_b32 v134, 0x2000, v130
    v_xor_b32 v135, 0x2000, v131
    v_mfma_f32_16x16x32_bf16 v[96:99], a[16:19], a[8:11], v[96:99]
    ds_read_b64_tr_b16 a[50:51], v136 offset:9216
    v_lshlrev_b32 v44, 4, v1
    s_lshl_b32 s63, s32, 15
    v_mfma_f32_16x16x32_bf16 v[112:115], a[16:19], a[12:15], v[112:115]
    ds_read_b128 a[32:35], v15 offset:0
    s_add_u32 s63, s63, 28672
    v_add_u32 v0, s63, v44
    s_waitcnt lgkmcnt(5)
    v_mfma_f32_16x16x32_bf16 v[116:119], a[20:23], a[12:15], v[116:119]
    ds_read_b128 a[36:39], v15 offset:2048
    s_add_u32 m0, s42, 0
    v_xor_b32 v58, 0x8000, v0
    s_mov_b64 s[16:17], s[84:85]
    v_mfma_f32_16x16x32_bf16 v[100:103], a[20:23], a[8:11], v[100:103]
    buffer_load_dwordx4 v38, s[12:15], s35 offen offset:0 lds
    s_mov_b32 s18, 0x10000000
    s_mov_b32 s19, 0x20000
    v_mfma_f32_16x16x32_bf16 v[84:87], a[20:23], a[4:7], v[84:87]
    ds_read_b128 a[40:43], v17 offset:0
    s_mov_b64 s[20:21], s[80:81]
    s_mov_b32 s22, 0x200000
    v_mfma_f32_16x16x32_bf16 v[68:71], a[20:23], a[0:3], v[68:71]
    ds_read_b128 a[44:47], v17 offset:2048
    s_mov_b32 s23, 0x20000
    s_lshl_b32 s45, s28, 9
    v_mfma_f32_16x16x32_bf16 v[72:75], a[24:27], a[0:3], v[72:75]
    ds_read_b64_tr_b16 a[52:53], v137 offset:8192
    s_andn2_b32 s63, s47, 7
    s_add_u32 s45, s45, s63
    v_mfma_f32_16x16x32_bf16 v[88:91], a[24:27], a[4:7], v[88:91]
    buffer_load_dwordx4 v39, s[12:15], s35 offen offset:1024 lds
    s_lshl_b32 s45, s45, 11
    s_add_u32 s45, s45, 1048576
    v_mfma_f32_16x16x32_bf16 v[104:107], a[24:27], a[8:11], v[104:107]
    ds_read_b64_tr_b16 a[54:55], v137 offset:9216
    s_and_b32 s63, s2, 7
    s_lshl_b32 s63, s63, 2
    v_mfma_f32_16x16x32_bf16 v[120:123], a[24:27], a[12:15], v[120:123]
    ds_read_b64_tr_b16 a[56:57], v138 offset:8192
    s_add_u32 s63, s63, s30
    s_lshl_b32 s63, s63, 2
    s_waitcnt lgkmcnt(9)
    v_mfma_f32_16x16x32_bf16 v[124:127], a[28:31], a[12:15], v[124:127]
    ds_read_b64_tr_b16 a[58:59], v138 offset:9216
    s_add_u32 s63, s63, s32
    s_lshl_b32 s63, s63, 7
    v_mfma_f32_16x16x32_bf16 v[108:111], a[28:31], a[8:11], v[108:111]
    buffer_load_dwordx4 v57, s[12:15], s35 offen offset:2048 lds
    s_add_u32 s63, s63, 4096
    s_add_u32 s48, s84, s63
    s_addc_u32 s49, s85, 0
    v_mfma_f32_16x16x32_bf16 v[92:95], a[28:31], a[4:7], v[92:95]
    ds_read_b64_tr_b16 a[60:61], v139 offset:8192
    v_mfma_f32_16x16x32_bf16 v[76:79], a[28:31], a[0:3], v[76:79]
    ds_read_b64_tr_b16 a[62:63], v139 offset:9216
    s_waitcnt vmcnt(8)
    s_barrier
    s_waitcnt lgkmcnt(6)
    v_mfma_f32_16x16x32_bf16 v[64:67], a[48:51], a[32:35], v[64:67]
    ds_read_b64_tr_b16 a[16:17], v136 offset:32768
    s_and_b32 s35, s36, 15
    s_lshr_b64 s[36:37], s[36:37], 4
    s_lshr_b32 s67, s35, 1
    s_lshl_b32 s34, s35, 7
    s_mul_i32 s67, s67, s39
    s_lshl_b32 s35, s35, s38
    s_add_u32 s34, s34, s67
    s_add_u32 m0, s41, 32768
    v_mfma_f32_16x16x32_bf16 v[80:83], a[48:51], a[36:39], v[80:83]
    buffer_load_dwordx4 v22, s[8:11], s34 offen offset:0 lds
    v_mfma_f32_16x16x32_bf16 v[96:99], a[48:51], a[40:43], v[96:99]
    ds_read_b64_tr_b16 a[18:19], v136 offset:33792
    v_mfma_f32_16x16x32_bf16 v[112:115], a[48:51], a[44:47], v[112:115]
    ds_read_b128 a[0:3], v14 offset:32768
    s_waitcnt lgkmcnt(5)
    v_mfma_f32_16x16x32_bf16 v[116:119], a[52:55], a[44:47], v[116:119]
    ds_read_b128 a[4:7], v14 offset:34816
    v_mfma_f32_16x16x32_bf16 v[100:103], a[52:55], a[40:43], v[100:103]
    buffer_load_dwordx4 v23, s[8:11], s34 offen offset:1024 lds
    v_mfma_f32_16x16x32_bf16 v[84:87], a[52:55], a[36:39], v[84:87]
    ds_read_b128 a[8:11], v16 offset:32768
    v_mfma_f32_16x16x32_bf16 v[68:71], a[52:55], a[32:35], v[68:71]
    ds_read_b128 a[12:15], v16 offset:34816
    v_mfma_f32_16x16x32_bf16 v[72:75], a[56:59], a[32:35], v[72:75]
    ds_read_b64_tr_b16 a[20:21], v137 offset:32768
    v_mfma_f32_16x16x32_bf16 v[88:91], a[56:59], a[36:39], v[88:91]
    v_mfma_f32_16x16x32_bf16 v[104:107], a[56:59], a[40:43], v[104:107]
    ds_read_b64_tr_b16 a[22:23], v137 offset:33792
    buffer_load_dwordx4 v24, s[8:11], s34 offen offset:2048 lds
    v_mfma_f32_16x16x32_bf16 v[120:123], a[56:59], a[44:47], v[120:123]
    ds_read_b64_tr_b16 a[24:25], v138 offset:32768
    s_waitcnt lgkmcnt(9)
    v_mfma_f32_16x16x32_bf16 v[124:127], a[60:63], a[44:47], v[124:127]
    ds_read_b64_tr_b16 a[26:27], v138 offset:33792
    v_mfma_f32_16x16x32_bf16 v[108:111], a[60:63], a[40:43], v[108:111]
    v_mfma_f32_16x16x32_bf16 v[92:95], a[60:63], a[36:39], v[92:95]
    ds_read_b64_tr_b16 a[28:29], v139 offset:32768
    buffer_load_dwordx4 v25, s[8:11], s34 offen offset:3072 lds
    v_mfma_f32_16x16x32_bf16 v[76:79], a[60:63], a[32:35], v[76:79]
    ds_read_b64_tr_b16 a[30:31], v139 offset:33792
    s_waitcnt lgkmcnt(6)
    v_mfma_f32_16x16x32_bf16 v[64:67], a[16:19], a[0:3], v[64:67]
    ds_read_b64_tr_b16 a[48:49], v136 offset:40960
    v_mfma_f32_16x16x32_bf16 v[80:83], a[16:19], a[4:7], v[80:83]
    v_mfma_f32_16x16x32_bf16 v[96:99], a[16:19], a[8:11], v[96:99]
    ds_read_b64_tr_b16 a[50:51], v136 offset:41984
    s_add_u32 m0, s42, 32768
    v_mfma_f32_16x16x32_bf16 v[112:115], a[16:19], a[12:15], v[112:115]
    ds_read_b128 a[32:35], v15 offset:32768
    buffer_load_dwordx4 v38, s[12:15], s35 offen offset:0 lds
    s_waitcnt lgkmcnt(5)
    v_mfma_f32_16x16x32_bf16 v[116:119], a[20:23], a[12:15], v[116:119]
    ds_read_b128 a[36:39], v15 offset:34816
    v_mfma_f32_16x16x32_bf16 v[100:103], a[20:23], a[8:11], v[100:103]
    v_mfma_f32_16x16x32_bf16 v[84:87], a[20:23], a[4:7], v[84:87]
    ds_read_b128 a[40:43], v17 offset:32768
    v_mfma_f32_16x16x32_bf16 v[68:71], a[20:23], a[0:3], v[68:71]
    ds_read_b128 a[44:47], v17 offset:34816
    buffer_load_dwordx4 v39, s[12:15], s35 offen offset:1024 lds
    v_mfma_f32_16x16x32_bf16 v[72:75], a[24:27], a[0:3], v[72:75]
    ds_read_b64_tr_b16 a[52:53], v137 offset:40960
    v_mfma_f32_16x16x32_bf16 v[88:91], a[24:27], a[4:7], v[88:91]
    v_mfma_f32_16x16x32_bf16 v[104:107], a[24:27], a[8:11], v[104:107]
    ds_read_b64_tr_b16 a[54:55], v137 offset:41984
    v_mfma_f32_16x16x32_bf16 v[120:123], a[24:27], a[12:15], v[120:123]
    ds_read_b64_tr_b16 a[56:57], v138 offset:40960
    s_waitcnt lgkmcnt(9)
    v_mfma_f32_16x16x32_bf16 v[124:127], a[28:31], a[12:15], v[124:127]
    ds_read_b64_tr_b16 a[58:59], v138 offset:41984
    buffer_load_dwordx4 v57, s[12:15], s35 offen offset:2048 lds
    v_mfma_f32_16x16x32_bf16 v[108:111], a[28:31], a[8:11], v[108:111]
    v_mfma_f32_16x16x32_bf16 v[92:95], a[28:31], a[4:7], v[92:95]
    ds_read_b64_tr_b16 a[60:61], v139 offset:40960
    v_mfma_f32_16x16x32_bf16 v[76:79], a[28:31], a[0:3], v[76:79]
    ds_read_b64_tr_b16 a[62:63], v139 offset:41984
    s_waitcnt lgkmcnt(0)
    s_waitcnt vmcnt(7)
    s_barrier
    v_mfma_f32_16x16x32_bf16 v[64:67], a[48:51], a[32:35], v[64:67]
    ds_read_b64 v[208:209], v132
    v_mov_b32 v18, v56
    v_add_u32 v19, 0x10000, v56
    v_add_u32 v20, 0x20000, v56
    v_mfma_f32_16x16x32_bf16 v[80:83], a[48:51], a[36:39], v[80:83]
    ds_read_b64 v[210:211], v133
    s_and_b32 s35, s36, 15
    s_lshr_b64 s[36:37], s[36:37], 4
    s_lshr_b32 s67, s35, 1
    s_lshl_b32 s34, s35, 7
    s_mul_i32 s67, s67, s39
    s_lshl_b32 s35, s35, s38
    s_add_u32 s34, s34, s67
    s_add_u32 m0, s41, 65536
    s_nop 0
    buffer_load_dwordx4 v22, s[8:11], s34 offen offset:0 lds
    v_mfma_f32_16x16x32_bf16 v[96:99], a[48:51], a[40:43], v[96:99]
    ds_read_b64 v[212:213], v134
    v_mov_b32 v21, v140
    v_mfma_f32_16x16x32_bf16 v[112:115], a[48:51], a[44:47], v[112:115]
    ds_read_b64 v[214:215], v135
    v_mfma_f32_16x16x32_bf16 v[116:119], a[52:55], a[44:47], v[116:119]
    ds_read_b64 v[216:217], v132 offset:4096
    v_mfma_f32_16x16x32_bf16 v[100:103], a[52:55], a[40:43], v[100:103]
    ds_read_b64 v[218:219], v133 offset:4096
    buffer_load_dwordx4 v23, s[8:11], s34 offen offset:1024 lds
    v_mfma_f32_16x16x32_bf16 v[84:87], a[52:55], a[36:39], v[84:87]
    ds_read_b64 v[220:221], v134 offset:4096
    v_mfma_f32_16x16x32_bf16 v[68:71], a[52:55], a[32:35], v[68:71]
    ds_read_b64 v[222:223], v135 offset:4096
    v_mfma_f32_16x16x32_bf16 v[72:75], a[56:59], a[32:35], v[72:75]
    ds_read_b64 v[192:193], v128
    ds_read_b128 a[0:3], v2
    v_mfma_f32_16x16x32_bf16 v[88:91], a[56:59], a[36:39], v[88:91]
    ds_read_b64 v[194:195], v129
    buffer_load_dwordx4 v24, s[8:11], s34 offen offset:2048 lds
    ds_read_b64_tr_b16 v[6:7], v18 offset:0
    v_mfma_f32_16x16x32_bf16 v[104:107], a[56:59], a[40:43], v[104:107]
    ds_read_b64 v[196:197], v130
    ds_read_b64_tr_b16 v[8:9], v18 offset:768
    v_mfma_f32_16x16x32_bf16 v[120:123], a[56:59], a[44:47], v[120:123]
    ds_read_b64 v[198:199], v131
    ds_read_b64_tr_b16 v[14:15], v18 offset:64
    v_mfma_f32_16x16x32_bf16 v[124:127], a[60:63], a[44:47], v[124:127]
    ds_read_b64 v[200:201], v128 offset:4096
    ds_read_b64_tr_b16 v[16:17], v18 offset:832
    v_mfma_f32_16x16x32_bf16 v[108:111], a[60:63], a[40:43], v[108:111]
    ds_read_b64 v[202:203], v129 offset:4096
    buffer_load_dwordx4 v25, s[8:11], s34 offen offset:3072 lds
    s_add_u32 m0, s42, 65536
    ds_read_b64_tr_b16 v[26:27], v18 offset:128
    v_mfma_f32_16x16x32_bf16 v[92:95], a[60:63], a[36:39], v[92:95]
    ds_read_b64 v[204:205], v130 offset:4096
    ds_read_b64_tr_b16 v[28:29], v18 offset:896
    v_mfma_f32_16x16x32_bf16 v[76:79], a[60:63], a[32:35], v[76:79]
    ds_read_b64 v[206:207], v131 offset:4096
    ds_read_b128 a[4:7], v3
    ds_read_b64_tr_b16 v[30:31], v18 offset:3072
    ds_read_b64_tr_b16 v[32:33], v18 offset:3840
    ds_read_b64_tr_b16 v[34:35], v18 offset:3136
    ds_read_b64_tr_b16 v[36:37], v18 offset:3904
    v_readfirstlane_b32 s44, v45
    s_mov_b32 s61, 0x3e0293ee
    s_lshl_b32 s62, s31, 11
    s_add_u32 s62, s62, s45
    s_cmp_eq_u32 s44, 0
    s_cbranch_scc1 L_nonce_spin
L_nonce_ok:
    v_cvt_pk_bf16_f32 v176, v96, v97
    v_cvt_pk_bf16_f32 v177, v98, v99
    v_cvt_pk_bf16_f32 v178, v100, v101
    v_cvt_pk_bf16_f32 v179, v102, v103
    v_cvt_pk_bf16_f32 v180, v104, v105
    v_cvt_pk_bf16_f32 v181, v106, v107
    v_cvt_pk_bf16_f32 v182, v108, v109
    v_cvt_pk_bf16_f32 v183, v110, v111
    s_waitcnt lgkmcnt(15)
    v_mfma_f32_16x16x32_bf16 v[240:243], v[208:211], v[176:179], 0
    v_cvt_pk_bf16_f32 v184, v112, v113
    v_cvt_pk_bf16_f32 v185, v114, v115
    v_cvt_pk_bf16_f32 v186, v116, v117
    buffer_load_dwordx4 v38, s[12:15], s35 offen offset:0 lds
    v_mfma_f32_16x16x32_bf16 v[244:247], v[216:219], v[176:179], 0
    v_cvt_pk_bf16_f32 v187, v118, v119
    v_cvt_pk_bf16_f32 v188, v120, v121
    v_cvt_pk_bf16_f32 v189, v122, v123
    v_mfma_f32_16x16x32_bf16 v[240:243], v[212:215], v[180:183], v[240:243]
    v_cvt_pk_bf16_f32 v190, v124, v125
    v_cvt_pk_bf16_f32 v191, v126, v127
    v_cvt_pk_bf16_f32 v160, v64, v65
    buffer_load_dwordx4 v39, s[12:15], s35 offen offset:1024 lds
    v_mfma_f32_16x16x32_bf16 v[244:247], v[220:223], v[180:183], v[244:247]
    v_cvt_pk_bf16_f32 v161, v66, v67
    v_cvt_pk_bf16_f32 v162, v68, v69
    v_cvt_pk_bf16_f32 v163, v70, v71
    v_mfma_f32_16x16x32_bf16 v[248:251], v[208:211], v[184:187], 0
    v_cvt_pk_bf16_f32 v164, v72, v73
    v_cvt_pk_bf16_f32 v165, v74, v75
    v_cvt_pk_bf16_f32 v166, v76, v77
    buffer_load_dwordx4 v57, s[12:15], s35 offen offset:2048 lds
    v_mfma_f32_16x16x32_bf16 v[252:255], v[216:219], v[184:187], 0
    v_cvt_pk_bf16_f32 v167, v78, v79
    v_cvt_pk_bf16_f32 v168, v80, v81
    v_cvt_pk_bf16_f32 v169, v82, v83
    v_mfma_f32_16x16x32_bf16 v[248:251], v[212:215], v[188:191], v[248:251]
    v_cvt_pk_bf16_f32 v170, v84, v85
    v_cvt_pk_bf16_f32 v171, v86, v87
    v_cvt_pk_bf16_f32 v172, v88, v89
    s_and_b32 s35, s36, 15
    s_lshr_b64 s[36:37], s[36:37], 4
    s_lshr_b32 s67, s35, 1
    s_lshl_b32 s34, s35, 7
    s_mul_i32 s67, s67, s39
    s_lshl_b32 s35, s35, s38
    s_add_u32 s34, s34, s67
    s_add_u32 m0, s41, 98304
    v_mfma_f32_16x16x32_bf16 v[252:255], v[220:223], v[188:191], v[252:255]
    v_cvt_pk_bf16_f32 v173, v90, v91
    v_cvt_pk_bf16_f32 v174, v92, v93
    v_cvt_pk_bf16_f32 v175, v94, v95
    s_waitcnt lgkmcnt(14)
    v_mfma_f32_32x32x16_bf16 v[112:127], a[0:3], v[6:9], 0
    ds_read_b64_tr_b16 v[52:53], v18 offset:3200
    ds_read_b64_tr_b16 v[54:55], v18 offset:3968
    buffer_load_dwordx4 v22, s[8:11], s34 offen offset:0 lds
    s_waitcnt lgkmcnt(7)
    v_mfma_f32_16x16x32_bf16 v[224:227], v[192:195], v[160:163], 0
    v_mfma_f32_16x16x32_bf16 v[228:231], v[200:203], v[160:163], 0
    v_mfma_f32_32x32x16_bf16 v[128:143], a[0:3], v[14:17], 0
    ds_read_b128 a[8:11], v4
    ds_read_b64_tr_b16 v[6:7], v18 offset:6144
    ds_read_b64_tr_b16 v[8:9], v18 offset:6912
    buffer_load_dwordx4 v23, s[8:11], s34 offen offset:1024 lds
    v_mfma_f32_16x16x32_bf16 v[224:227], v[196:199], v[164:167], v[224:227]
    v_mfma_f32_16x16x32_bf16 v[228:231], v[204:207], v[164:167], v[228:231]
    v_mfma_f32_32x32x16_bf16 v[144:159], a[0:3], v[26:29], 0
    ds_read_b64_tr_b16 v[14:15], v18 offset:6208
    ds_read_b64_tr_b16 v[16:17], v18 offset:6976
    buffer_load_dwordx4 v24, s[8:11], s34 offen offset:2048 lds
    v_mfma_f32_16x16x32_bf16 v[232:235], v[192:195], v[168:171], 0
    v_mfma_f32_16x16x32_bf16 v[236:239], v[200:203], v[168:171], 0
    s_waitcnt lgkmcnt(9)
    v_mfma_f32_32x32x16_bf16 v[112:127], a[4:7], v[30:33], v[112:127]
    ds_read_b64_tr_b16 v[26:27], v18 offset:6272
    ds_read_b64_tr_b16 v[28:29], v18 offset:7040
    buffer_load_dwordx4 v25, s[8:11], s34 offen offset:3072 lds
    s_add_u32 m0, s42, 98304
    v_mfma_f32_16x16x32_bf16 v[232:235], v[196:199], v[172:175], v[232:235]
    v_mfma_f32_16x16x32_bf16 v[236:239], v[204:207], v[172:175], v[236:239]
    s_waitcnt lgkmcnt(9)
    v_mfma_f32_32x32x16_bf16 v[128:143], a[4:7], v[34:37], v[128:143]
    ds_read_b128 a[12:15], v5
    ds_read_b64_tr_b16 v[30:31], v18 offset:9216
    ds_read_b64_tr_b16 v[32:33], v18 offset:9984
    buffer_load_dwordx4 v38, s[12:15], s35 offen offset:0 lds
    ds_write_b128 v58, v[240:243] offset:0
    ds_write_b128 v58, v[244:247] offset:1024
    s_waitcnt lgkmcnt(12)
    v_mfma_f32_32x32x16_bf16 v[144:159], a[4:7], v[52:55], v[144:159]
    ds_read_b64_tr_b16 v[34:35], v18 offset:9280
    ds_read_b64_tr_b16 v[36:37], v18 offset:10048
    buffer_load_dwordx4 v39, s[12:15], s35 offen offset:1024 lds
    ds_write_b128 v58, v[248:251] offset:2048
    ds_write_b128 v58, v[252:255] offset:3072
    s_waitcnt lgkmcnt(13)
    v_mfma_f32_32x32x16_bf16 v[112:127], a[8:11], v[6:9], v[112:127]
    ds_read_b64_tr_b16 v[52:53], v18 offset:9344
    ds_read_b64_tr_b16 v[54:55], v18 offset:10112
    buffer_load_dwordx4 v57, s[12:15], s35 offen offset:2048 lds
    s_waitcnt lgkmcnt(13)
    v_mfma_f32_32x32x16_bf16 v[128:143], a[8:11], v[14:17], v[128:143]
    s_waitcnt lgkmcnt(2)
    s_waitcnt vmcnt(14)
    s_barrier
    ds_read_b128 v[192:195], v0 offset:0
    ds_read_b128 v[196:199], v0 offset:1024
    ds_read_b128 v[200:203], v0 offset:2048
    ds_read_b128 v[204:207], v0 offset:3072
    ds_read_b128 a[16:19], v2 offset:32768
    ds_read_b64_tr_b16 v[6:7], v18 offset:32768
    ds_read_b64_tr_b16 v[8:9], v18 offset:33536
    s_and_b32 s35, s36, 15
    s_lshr_b64 s[36:37], s[36:37], 4
    s_lshr_b32 s67, s35, 1
    s_lshl_b32 s34, s35, 7
    s_mul_i32 s67, s67, s39
    s_lshl_b32 s35, s35, s38
    s_add_u32 s34, s34, s67
    s_add_u32 m0, s41, 131072
    s_nop 0
    buffer_load_dwordx4 v22, s[8:11], s34 offen offset:0 lds
    s_waitcnt lgkmcnt(3)
    v_add_f32 v224, v224, v192
    v_add_f32 v225, v225, v193
    v_add_f32 v226, v226, v194
    v_add_f32 v227, v227, v195
    v_add_f32 v228, v228, v196
    v_mfma_f32_32x32x16_bf16 v[144:159], a[8:11], v[26:29], v[144:159]
    ds_read_b64_tr_b16 v[14:15], v18 offset:32832
    ds_read_b64_tr_b16 v[16:17], v18 offset:33600
    buffer_load_dwordx4 v23, s[8:11], s34 offen offset:1024 lds
    v_add_f32 v229, v229, v197
    v_add_f32 v230, v230, v198
    v_add_f32 v231, v231, v199
    v_add_f32 v232, v232, v200
    v_add_f32 v233, v233, v201
    v_add_f32 v234, v234, v202
    v_mfma_f32_32x32x16_bf16 v[112:127], a[12:15], v[30:33], v[112:127]
    ds_read_b64_tr_b16 v[26:27], v18 offset:32896
    ds_read_b64_tr_b16 v[28:29], v18 offset:33664
    v_add_f32 v235, v235, v203
    v_add_f32 v236, v236, v204
    v_add_f32 v237, v237, v205
    v_add_f32 v238, v238, v206
    v_add_f32 v239, v239, v207
    v_max3_f32 v46, v224, v225, v226
    v_mfma_f32_32x32x16_bf16 v[128:143], a[12:15], v[34:37], v[128:143]
    ds_read_b128 a[20:23], v3 offset:32768
    ds_read_b64_tr_b16 v[30:31], v18 offset:35840
    ds_read_b64_tr_b16 v[32:33], v18 offset:36608
    buffer_load_dwordx4 v24, s[8:11], s34 offen offset:2048 lds
    v_max3_f32 v47, v232, v233, v234
    v_max3_f32 v46, v46, v227, v228
    v_max3_f32 v47, v47, v235, v236
    v_max3_f32 v46, v46, v229, v230
    v_max3_f32 v47, v47, v237, v238
    v_max_f32 v46, v46, v231
    v_mfma_f32_32x32x16_bf16 v[144:159], a[12:15], v[52:55], v[144:159]
    ds_read_b64_tr_b16 v[34:35], v18 offset:35904
    ds_read_b64_tr_b16 v[36:37], v18 offset:36672
    v_max_f32 v47, v47, v239
    v_mov_b32 v48, v46
    v_mov_b32 v49, v47
    s_nop 0
    v_permlane16_swap_b32 v46, v48
    v_permlane16_swap_b32 v47, v49
    v_max_f32 v46, v46, v48
    v_max_f32 v47, v47, v49
    v_mov_b32 v48, v46
    v_mov_b32 v49, v47
    s_nop 0
    v_permlane32_swap_b32 v46, v48
    v_permlane32_swap_b32 v47, v49
    v_max_f32 v46, v46, v48
    s_waitcnt lgkmcnt(9)
    v_mfma_f32_32x32x16_bf16 v[112:127], a[16:19], v[6:9], v[112:127]
    ds_read_b64_tr_b16 v[52:53], v18 offset:35968
    ds_read_b64_tr_b16 v[54:55], v18 offset:36736
    buffer_load_dwordx4 v25, s[8:11], s34 offen offset:3072 lds
    s_add_u32 m0, s42, 131072
    v_max_f32 v47, v47, v49
    v_mul_f32 v46, s61, v46
    v_mul_f32 v47, s61, v47
    v_fma_f32 v224, v224, s61, -v46
    v_fma_f32 v225, v225, s61, -v46
    v_fma_f32 v226, v226, s61, -v46
    s_waitcnt lgkmcnt(9)
    v_mfma_f32_32x32x16_bf16 v[128:143], a[16:19], v[14:17], v[128:143]
    ds_read_b128 a[24:27], v4 offset:32768
    ds_read_b64_tr_b16 v[6:7], v18 offset:38912
    ds_read_b64_tr_b16 v[8:9], v18 offset:39680
    buffer_load_dwordx4 v38, s[12:15], s35 offen offset:0 lds
    v_fma_f32 v227, v227, s61, -v46
    v_fma_f32 v228, v228, s61, -v46
    v_fma_f32 v229, v229, s61, -v46
    v_fma_f32 v230, v230, s61, -v46
    v_fma_f32 v231, v231, s61, -v46
    v_fma_f32 v232, v232, s61, -v47
    s_waitcnt lgkmcnt(10)
    v_mfma_f32_32x32x16_bf16 v[144:159], a[16:19], v[26:29], v[144:159]
    ds_read_b64_tr_b16 v[14:15], v18 offset:38976
    ds_read_b64_tr_b16 v[16:17], v18 offset:39744
    v_fma_f32 v233, v233, s61, -v47
    v_fma_f32 v234, v234, s61, -v47
    v_fma_f32 v235, v235, s61, -v47
    v_fma_f32 v236, v236, s61, -v47
    v_fma_f32 v237, v237, s61, -v47
    v_fma_f32 v238, v238, s61, -v47
    s_waitcnt lgkmcnt(9)
    v_mfma_f32_32x32x16_bf16 v[112:127], a[20:23], v[30:33], v[112:127]
    ds_read_b64_tr_b16 v[26:27], v18 offset:39040
    ds_read_b64_tr_b16 v[28:29], v18 offset:39808
    buffer_load_dwordx4 v39, s[12:15], s35 offen offset:1024 lds
    v_fma_f32 v239, v239, s61, -v47
    v_exp_f32 v224, v224
    v_exp_f32 v225, v225
    v_exp_f32 v226, v226
    v_exp_f32 v227, v227
    v_exp_f32 v228, v228
    s_waitcnt lgkmcnt(9)
    v_mfma_f32_32x32x16_bf16 v[128:143], a[20:23], v[34:37], v[128:143]
    ds_read_b128 a[28:31], v5 offset:32768
    ds_read_b64_tr_b16 v[30:31], v18 offset:41984
    ds_read_b64_tr_b16 v[32:33], v18 offset:42752
    v_exp_f32 v229, v229
    v_exp_f32 v230, v230
    v_exp_f32 v231, v231
    v_exp_f32 v232, v232
    v_exp_f32 v233, v233
    v_exp_f32 v234, v234
    s_waitcnt lgkmcnt(10)
    v_mfma_f32_32x32x16_bf16 v[144:159], a[20:23], v[52:55], v[144:159]
    ds_read_b64_tr_b16 v[34:35], v18 offset:42048
    ds_read_b64_tr_b16 v[36:37], v18 offset:42816
    buffer_load_dwordx4 v57, s[12:15], s35 offen offset:2048 lds
    v_exp_f32 v235, v235
    v_exp_f32 v236, v236
    v_exp_f32 v237, v237
    v_exp_f32 v238, v238
    v_exp_f32 v239, v239
    v_add_f32 v46, v224, v225
    s_waitcnt lgkmcnt(9)
    v_mfma_f32_32x32x16_bf16 v[112:127], a[24:27], v[6:9], v[112:127]
    ds_read_b64_tr_b16 v[52:53], v18 offset:42112
    ds_read_b64_tr_b16 v[54:55], v18 offset:42880
    v_add_f32 v47, v232, v233
    v_add_f32 v46, v46, v226
    v_add_f32 v47, v47, v234
    v_add_f32 v46, v46, v227
    v_add_f32 v47, v47, v235
    v_add_f32 v46, v46, v228
    s_waitcnt lgkmcnt(9)
    v_mfma_f32_32x32x16_bf16 v[128:143], a[24:27], v[14:17], v[128:143]
    s_waitcnt vmcnt(14)
    s_barrier
    ds_read_b128 a[32:35], v10
    ds_read_b64_tr_b16 v[6:7], v19 offset:0
    ds_read_b64_tr_b16 v[8:9], v19 offset:768
    s_and_b32 s35, s36, 15
    s_lshr_b64 s[36:37], s[36:37], 4
    s_lshr_b32 s67, s35, 1
    s_lshl_b32 s34, s35, 7
    s_mul_i32 s67, s67, s39
    s_lshl_b32 s35, s35, s38
    s_add_u32 s34, s34, s67
    s_add_u32 m0, s41, 0
    s_nop 0
    buffer_load_dwordx4 v22, s[8:11], s34 offen offset:0 lds
    v_add_f32 v47, v47, v236
    v_add_f32 v46, v46, v229
    v_add_f32 v47, v47, v237
    v_add_f32 v46, v46, v230
    v_add_f32 v47, v47, v238
    v_add_f32 v46, v46, v231
    s_waitcnt lgkmcnt(10)
    v_mfma_f32_32x32x16_bf16 v[144:159], a[24:27], v[26:29], v[144:159]
    ds_read_b64_tr_b16 v[14:15], v19 offset:64
    ds_read_b64_tr_b16 v[16:17], v19 offset:832
    buffer_load_dwordx4 v23, s[8:11], s34 offen offset:1024 lds
    v_add_f32 v47, v47, v239
    v_mov_b32 v48, v46
    v_mov_b32 v49, v47
    s_nop 0
    v_permlane16_swap_b32 v46, v48
    v_permlane16_swap_b32 v47, v49
    v_add_f32 v46, v46, v48
    v_add_f32 v47, v47, v49
    v_mov_b32 v48, v46
    v_mov_b32 v49, v47
    s_nop 0
    v_permlane32_swap_b32 v46, v48
    v_permlane32_swap_b32 v47, v49
    v_add_f32 v46, v46, v48
    s_waitcnt lgkmcnt(9)
    v_mfma_f32_32x32x16_bf16 v[112:127], a[28:31], v[30:33], v[112:127]
    ds_read_b64_tr_b16 v[26:27], v19 offset:128
    ds_read_b64_tr_b16 v[28:29], v19 offset:896
    v_add_f32 v47, v47, v49
    v_rcp_f32 v46, v46
    v_rcp_f32 v47, v47
    v_mul_f32 v224, v224, v46
    v_mul_f32 v225, v225, v46
    v_mul_f32 v226, v226, v46
    s_waitcnt lgkmcnt(9)
    v_mfma_f32_32x32x16_bf16 v[128:143], a[28:31], v[34:37], v[128:143]
    ds_read_b128 a[36:39], v11
    ds_read_b64_tr_b16 v[30:31], v19 offset:3072
    ds_read_b64_tr_b16 v[32:33], v19 offset:3840
    buffer_load_dwordx4 v24, s[8:11], s34 offen offset:2048 lds
    v_mul_f32 v227, v227, v46
    v_mul_f32 v228, v228, v46
    v_mul_f32 v229, v229, v46
    v_mul_f32 v230, v230, v46
    v_mul_f32 v231, v231, v46
    v_mul_f32 v232, v232, v47
    s_waitcnt lgkmcnt(10)
    v_mfma_f32_32x32x16_bf16 v[144:159], a[28:31], v[52:55], v[144:159]
    ds_read_b64_tr_b16 v[34:35], v19 offset:3136
    ds_read_b64_tr_b16 v[36:37], v19 offset:3904
    v_mul_f32 v233, v233, v47
    v_mul_f32 v234, v234, v47
    v_mul_f32 v235, v235, v47
    v_mul_f32 v236, v236, v47
    v_mul_f32 v237, v237, v47
    v_mul_f32 v238, v238, v47
    s_waitcnt lgkmcnt(9)
    v_mfma_f32_32x32x16_bf16 v[64:79], a[32:35], v[6:9], 0
    ds_read_b64_tr_b16 v[52:53], v19 offset:3200
    ds_read_b64_tr_b16 v[54:55], v19 offset:3968
    buffer_load_dwordx4 v25, s[8:11], s34 offen offset:3072 lds
    s_add_u32 m0, s42, 0
    v_mul_f32 v239, v239, v47
    v_cvt_pk_bf16_f32 v192, v224, v225
    v_cvt_pk_bf16_f32 v193, v226, v227
    v_cvt_pk_bf16_f32 v194, v228, v229
    v_cvt_pk_bf16_f32 v195, v230, v231
    v_cvt_pk_bf16_f32 v196, v232, v233
    s_waitcnt lgkmcnt(9)
    v_mfma_f32_32x32x16_bf16 v[80:95], a[32:35], v[14:17], 0
    ds_read_b128 a[40:43], v12
    ds_read_b64_tr_b16 v[6:7], v19 offset:6144
    ds_read_b64_tr_b16 v[8:9], v19 offset:6912
    buffer_load_dwordx4 v38, s[12:15], s35 offen offset:0 lds
    v_cvt_pk_bf16_f32 v197, v234, v235
    v_cvt_pk_bf16_f32 v198, v236, v237
    v_cvt_pk_bf16_f32 v199, v238, v239
    buffer_store_dwordx2 v[192:193], v21, s[16:19], s62 offen offset:0 sc1
    buffer_store_dwordx2 v[194:195], v21, s[16:19], s62 offen offset:1024 sc1
    buffer_store_dwordx2 v[196:197], v21, s[16:19], s62 offen offset:256 sc1
    s_waitcnt lgkmcnt(10)
    v_mfma_f32_32x32x16_bf16 v[96:111], a[32:35], v[26:29], 0
    ds_read_b64_tr_b16 v[14:15], v19 offset:6208
    ds_read_b64_tr_b16 v[16:17], v19 offset:6976
    buffer_store_dwordx2 v[198:199], v21, s[16:19], s62 offen offset:1280 sc1
    s_nop 3
    v_cvt_pk_bf16_f32 v160, v112, v113
    v_cvt_pk_bf16_f32 v161, v114, v115
    v_cvt_pk_bf16_f32 v162, v116, v117
    v_cvt_pk_bf16_f32 v163, v118, v119
    s_waitcnt lgkmcnt(9)
    v_mfma_f32_32x32x16_bf16 v[64:79], a[36:39], v[30:33], v[64:79]
    ds_read_b64_tr_b16 v[26:27], v19 offset:6272
    ds_read_b64_tr_b16 v[28:29], v19 offset:7040
    buffer_load_dwordx4 v39, s[12:15], s35 offen offset:1024 lds
    v_cvt_pk_bf16_f32 v164, v120, v121
    v_cvt_pk_bf16_f32 v165, v122, v123
    v_cvt_pk_bf16_f32 v166, v124, v125
    v_cvt_pk_bf16_f32 v167, v126, v127
    v_cvt_pk_bf16_f32 v168, v128, v129
    v_cvt_pk_bf16_f32 v169, v130, v131
    s_waitcnt lgkmcnt(9)
    v_mfma_f32_32x32x16_bf16 v[80:95], a[36:39], v[34:37], v[80:95]
    ds_read_b128 a[44:47], v13
    ds_read_b64_tr_b16 v[30:31], v19 offset:9216
    ds_read_b64_tr_b16 v[32:33], v19 offset:9984
    v_cvt_pk_bf16_f32 v170, v132, v133
    v_cvt_pk_bf16_f32 v171, v134, v135
    v_cvt_pk_bf16_f32 v172, v136, v137
    v_cvt_pk_bf16_f32 v173, v138, v139
    v_cvt_pk_bf16_f32 v174, v140, v141
    v_cvt_pk_bf16_f32 v175, v142, v143
    s_waitcnt lgkmcnt(10)
    v_mfma_f32_32x32x16_bf16 v[96:111], a[36:39], v[52:55], v[96:111]
    ds_read_b64_tr_b16 v[34:35], v19 offset:9280
    ds_read_b64_tr_b16 v[36:37], v19 offset:10048
    buffer_load_dwordx4 v57, s[12:15], s35 offen offset:2048 lds
    v_cvt_pk_bf16_f32 v176, v144, v145
    v_cvt_pk_bf16_f32 v177, v146, v147
    v_cvt_pk_bf16_f32 v178, v148, v149
    v_cvt_pk_bf16_f32 v179, v150, v151
    v_cvt_pk_bf16_f32 v180, v152, v153
    v_cvt_pk_bf16_f32 v181, v154, v155
    s_waitcnt lgkmcnt(9)
    v_mfma_f32_32x32x16_bf16 v[64:79], a[40:43], v[6:9], v[64:79]
    ds_read_b64_tr_b16 v[52:53], v19 offset:9344
    ds_read_b64_tr_b16 v[54:55], v19 offset:10112
    v_cvt_pk_bf16_f32 v182, v156, v157
    v_cvt_pk_bf16_f32 v183, v158, v159
    s_waitcnt lgkmcnt(9)
    v_mfma_f32_32x32x16_bf16 v[80:95], a[40:43], v[14:17], v[80:95]
    s_waitcnt vmcnt(18)
    s_barrier
    ds_read_b128 a[48:51], v10 offset:32768
    ds_read_b64_tr_b16 v[6:7], v19 offset:32768
    ds_read_b64_tr_b16 v[8:9], v19 offset:33536
    s_and_b32 s35, s36, 15
    s_lshr_b64 s[36:37], s[36:37], 4
    s_lshr_b32 s67, s35, 1
    s_lshl_b32 s34, s35, 7
    s_mul_i32 s67, s67, s39
    s_lshl_b32 s35, s35, s38
    s_add_u32 s34, s34, s67
    s_add_u32 m0, s41, 32768
    s_nop 0
    buffer_load_dwordx4 v22, s[8:11], s34 offen offset:0 lds
    s_waitcnt lgkmcnt(10)
    v_mfma_f32_32x32x16_bf16 v[96:111], a[40:43], v[26:29], v[96:111]
    ds_read_b64_tr_b16 v[14:15], v19 offset:32832
    ds_read_b64_tr_b16 v[16:17], v19 offset:33600
    buffer_load_dwordx4 v23, s[8:11], s34 offen offset:1024 lds
    s_waitcnt lgkmcnt(9)
    v_mfma_f32_32x32x16_bf16 v[64:79], a[44:47], v[30:33], v[64:79]
    ds_read_b64_tr_b16 v[26:27], v19 offset:32896
    ds_read_b64_tr_b16 v[28:29], v19 offset:33664
    s_waitcnt lgkmcnt(9)
    v_mfma_f32_32x32x16_bf16 v[80:95], a[44:47], v[34:37], v[80:95]
    ds_read_b128 a[52:55], v11 offset:32768
    ds_read_b64_tr_b16 v[30:31], v19 offset:35840
    ds_read_b64_tr_b16 v[32:33], v19 offset:36608
    buffer_load_dwordx4 v24, s[8:11], s34 offen offset:2048 lds
    s_waitcnt lgkmcnt(10)
    v_mfma_f32_32x32x16_bf16 v[96:111], a[44:47], v[52:55], v[96:111]
    ds_read_b64_tr_b16 v[34:35], v19 offset:35904
    ds_read_b64_tr_b16 v[36:37], v19 offset:36672
    s_waitcnt lgkmcnt(9)
    v_mfma_f32_32x32x16_bf16 v[64:79], a[48:51], v[6:9], v[64:79]
    ds_read_b64_tr_b16 v[52:53], v19 offset:35968
    ds_read_b64_tr_b16 v[54:55], v19 offset:36736
    buffer_load_dwordx4 v25, s[8:11], s34 offen offset:3072 lds
    s_add_u32 m0, s42, 32768
    s_waitcnt lgkmcnt(9)
    v_mfma_f32_32x32x16_bf16 v[80:95], a[48:51], v[14:17], v[80:95]
    ds_read_b128 a[56:59], v12 offset:32768
    ds_read_b64_tr_b16 v[6:7], v19 offset:38912
    ds_read_b64_tr_b16 v[8:9], v19 offset:39680
    buffer_load_dwordx4 v38, s[12:15], s35 offen offset:0 lds
    s_waitcnt lgkmcnt(10)
    v_mfma_f32_32x32x16_bf16 v[96:111], a[48:51], v[26:29], v[96:111]
    ds_read_b64_tr_b16 v[14:15], v19 offset:38976
    ds_read_b64_tr_b16 v[16:17], v19 offset:39744
    s_waitcnt lgkmcnt(9)
    v_mfma_f32_32x32x16_bf16 v[64:79], a[52:55], v[30:33], v[64:79]
    ds_read_b64_tr_b16 v[26:27], v19 offset:39040
    ds_read_b64_tr_b16 v[28:29], v19 offset:39808
    buffer_load_dwordx4 v39, s[12:15], s35 offen offset:1024 lds
    s_waitcnt lgkmcnt(9)
    v_mfma_f32_32x32x16_bf16 v[80:95], a[52:55], v[34:37], v[80:95]
    ds_read_b128 a[60:63], v13 offset:32768
    ds_read_b64_tr_b16 v[30:31], v19 offset:41984
    ds_read_b64_tr_b16 v[32:33], v19 offset:42752
    s_waitcnt lgkmcnt(10)
    v_mfma_f32_32x32x16_bf16 v[96:111], a[52:55], v[52:55], v[96:111]
    ds_read_b64_tr_b16 v[34:35], v19 offset:42048
    ds_read_b64_tr_b16 v[36:37], v19 offset:42816
    buffer_load_dwordx4 v57, s[12:15], s35 offen offset:2048 lds
    s_waitcnt lgkmcnt(9)
    v_mfma_f32_32x32x16_bf16 v[64:79], a[56:59], v[6:9], v[64:79]
    ds_read_b64_tr_b16 v[52:53], v19 offset:42112
    ds_read_b64_tr_b16 v[54:55], v19 offset:42880
    s_waitcnt lgkmcnt(9)
    v_mfma_f32_32x32x16_bf16 v[80:95], a[56:59], v[14:17], v[80:95]
    s_waitcnt vmcnt(18)
    s_barrier
    ds_read_b128 a[64:67], v40
    ds_read_b64_tr_b16 v[6:7], v20 offset:0
    ds_read_b64_tr_b16 v[8:9], v20 offset:768
    s_waitcnt vmcnt(9)
    s_lshl_b32 s66, s31, 2
    v_mov_b32 v50, s44
    v_mov_b32 v51, s66
    s_mov_b64 exec, 1
    global_store_dword v51, v50, s[48:49] sc1
    s_mov_b64 exec, -1
    buffer_load_dwordx4 v[232:235], v44, s[16:19], s62 offen sc1
    buffer_load_dwordx4 v[236:239], v44, s[16:19], s62 offen offset:1024 sc1
    s_and_b32 s35, s36, 15
    s_lshr_b64 s[36:37], s[36:37], 4
    s_lshr_b32 s67, s35, 1
    s_lshl_b32 s34, s35, 7
    s_mul_i32 s67, s67, s39
    s_lshl_b32 s35, s35, s38
    s_add_u32 s34, s34, s67
    s_add_u32 m0, s41, 65536
    s_nop 0
    buffer_load_dwordx4 v22, s[8:11], s34 offen offset:0 lds
    s_waitcnt lgkmcnt(10)
    v_mfma_f32_32x32x16_bf16 v[96:111], a[56:59], v[26:29], v[96:111]
    ds_read_b64_tr_b16 v[14:15], v20 offset:64
    ds_read_b64_tr_b16 v[16:17], v20 offset:832
    buffer_load_dwordx4 v23, s[8:11], s34 offen offset:1024 lds
    s_waitcnt lgkmcnt(9)
    v_mfma_f32_32x32x16_bf16 v[64:79], a[60:63], v[30:33], v[64:79]
    ds_read_b64_tr_b16 v[26:27], v20 offset:128
    ds_read_b64_tr_b16 v[28:29], v20 offset:896
    s_waitcnt lgkmcnt(9)
    v_mfma_f32_32x32x16_bf16 v[80:95], a[60:63], v[34:37], v[80:95]
    ds_read_b128 a[68:71], v41
    ds_read_b64_tr_b16 v[30:31], v20 offset:3072
    ds_read_b64_tr_b16 v[32:33], v20 offset:3840
    buffer_load_dwordx4 v24, s[8:11], s34 offen offset:2048 lds
    s_waitcnt lgkmcnt(10)
    v_mfma_f32_32x32x16_bf16 v[96:111], a[60:63], v[52:55], v[96:111]
    ds_read_b64_tr_b16 v[34:35], v20 offset:3136
    ds_read_b64_tr_b16 v[36:37], v20 offset:3904
    s_waitcnt lgkmcnt(9)
    v_mfma_f32_32x32x16_bf16 v[112:127], a[64:67], v[6:9], 0
    ds_read_b64_tr_b16 v[52:53], v20 offset:3200
    ds_read_b64_tr_b16 v[54:55], v20 offset:3968
    buffer_load_dwordx4 v25, s[8:11], s34 offen offset:3072 lds
    s_add_u32 m0, s42, 65536
    s_nop 3
    v_cvt_pk_bf16_f32 v184, v64, v65
    v_cvt_pk_bf16_f32 v185, v66, v67
    s_waitcnt lgkmcnt(9)
    v_mfma_f32_32x32x16_bf16 v[128:143], a[64:67], v[14:17], 0
    ds_read_b128 a[72:75], v42
    ds_read_b64_tr_b16 v[6:7], v20 offset:6144
    ds_read_b64_tr_b16 v[8:9], v20 offset:6912
    buffer_load_dwordx4 v38, s[12:15], s35 offen offset:0 lds
    v_cvt_pk_bf16_f32 v186, v68, v69
    v_cvt_pk_bf16_f32 v187, v70, v71
    v_cvt_pk_bf16_f32 v188, v72, v73
    s_waitcnt lgkmcnt(10)
    v_mfma_f32_32x32x16_bf16 v[144:159], a[64:67], v[26:29], 0
    ds_read_b64_tr_b16 v[14:15], v20 offset:6208
    ds_read_b64_tr_b16 v[16:17], v20 offset:6976
    v_cvt_pk_bf16_f32 v189, v74, v75
    v_cvt_pk_bf16_f32 v190, v76, v77
    v_cvt_pk_bf16_f32 v191, v78, v79
    s_waitcnt lgkmcnt(9)
    v_mfma_f32_32x32x16_bf16 v[112:127], a[68:71], v[30:33], v[112:127]
    ds_read_b64_tr_b16 v[26:27], v20 offset:6272
    ds_read_b64_tr_b16 v[28:29], v20 offset:7040
    buffer_load_dwordx4 v39, s[12:15], s35 offen offset:1024 lds
    v_cvt_pk_bf16_f32 v192, v80, v81
    v_cvt_pk_bf16_f32 v193, v82, v83
    v_cvt_pk_bf16_f32 v194, v84, v85
    s_waitcnt lgkmcnt(9)
    v_mfma_f32_32x32x16_bf16 v[128:143], a[68:71], v[34:37], v[128:143]
    ds_read_b128 a[76:79], v43
    ds_read_b64_tr_b16 v[30:31], v20 offset:9216
    ds_read_b64_tr_b16 v[32:33], v20 offset:9984
    v_cvt_pk_bf16_f32 v195, v86, v87
    v_cvt_pk_bf16_f32 v196, v88, v89
    v_cvt_pk_bf16_f32 v197, v90, v91
    s_waitcnt lgkmcnt(10)
    v_mfma_f32_32x32x16_bf16 v[144:159], a[68:71], v[52:55], v[144:159]
    ds_read_b64_tr_b16 v[34:35], v20 offset:9280
    ds_read_b64_tr_b16 v[36:37], v20 offset:10048
    buffer_load_dwordx4 v57, s[12:15], s35 offen offset:2048 lds
    v_cvt_pk_bf16_f32 v198, v92, v93
    v_cvt_pk_bf16_f32 v199, v94, v95
    v_cvt_pk_bf16_f32 v200, v96, v97
    s_waitcnt lgkmcnt(9)
    v_mfma_f32_32x32x16_bf16 v[112:127], a[72:75], v[6:9], v[112:127]
    ds_read_b64_tr_b16 v[52:53], v20 offset:9344
    ds_read_b64_tr_b16 v[54:55], v20 offset:10112
    v_cvt_pk_bf16_f32 v201, v98, v99
    v_cvt_pk_bf16_f32 v202, v100, v101
    v_cvt_pk_bf16_f32 v203, v102, v103
    s_waitcnt lgkmcnt(9)
    v_mfma_f32_32x32x16_bf16 v[128:143], a[72:75], v[14:17], v[128:143]
    s_waitcnt vmcnt(17)
    s_barrier
    ds_read_b128 a[80:83], v2
    ds_read_b64_tr_b16 v[6:7], v18 offset:0
    ds_read_b64_tr_b16 v[8:9], v18 offset:768
    s_and_b32 s35, s36, 15
    s_lshr_b64 s[36:37], s[36:37], 4
    s_lshr_b32 s67, s35, 1
    s_lshl_b32 s34, s35, 7
    s_mul_i32 s67, s67, s39
    s_lshl_b32 s35, s35, s38
    s_add_u32 s34, s34, s67
    s_add_u32 m0, s41, 98304
    s_nop 0
    buffer_load_dwordx4 v22, s[8:11], s34 offen offset:0 lds
    s_load_dwordx8 s[52:59], s[48:49], 0 glc
    v_cvt_pk_bf16_f32 v204, v104, v105
    v_cvt_pk_bf16_f32 v205, v106, v107
    v_cvt_pk_bf16_f32 v206, v108, v109
    s_waitcnt lgkmcnt(10)
    v_mfma_f32_32x32x16_bf16 v[144:159], a[72:75], v[26:29], v[144:159]
    ds_read_b64_tr_b16 v[14:15], v18 offset:64
    ds_read_b64_tr_b16 v[16:17], v18 offset:832
    buffer_load_dwordx4 v23, s[8:11], s34 offen offset:1024 lds
    v_cvt_pk_bf16_f32 v207, v110, v111
    s_waitcnt lgkmcnt(9)
    v_mfma_f32_32x32x16_bf16 v[112:127], a[76:79], v[30:33], v[112:127]
    ds_read_b64_tr_b16 v[26:27], v18 offset:128
    ds_read_b64_tr_b16 v[28:29], v18 offset:896
    s_waitcnt lgkmcnt(9)
    v_mfma_f32_32x32x16_bf16 v[128:143], a[76:79], v[34:37], v[128:143]
    ds_read_b128 a[84:87], v3
    ds_read_b64_tr_b16 v[30:31], v18 offset:3072
    ds_read_b64_tr_b16 v[32:33], v18 offset:3840
    buffer_load_dwordx4 v24, s[8:11], s34 offen offset:2048 lds
    s_waitcnt lgkmcnt(10)
    v_mfma_f32_32x32x16_bf16 v[144:159], a[76:79], v[52:55], v[144:159]
    ds_read_b64_tr_b16 v[34:35], v18 offset:3136
    ds_read_b64_tr_b16 v[36:37], v18 offset:3904
    s_waitcnt lgkmcnt(9)
    v_mfma_f32_32x32x16_bf16 v[112:127], a[80:83], v[6:9], v[112:127]
    ds_read_b64_tr_b16 v[52:53], v18 offset:3200
    ds_read_b64_tr_b16 v[54:55], v18 offset:3968
    buffer_load_dwordx4 v25, s[8:11], s34 offen offset:3072 lds
    s_add_u32 m0, s42, 98304
    s_waitcnt lgkmcnt(9)
    v_mfma_f32_32x32x16_bf16 v[128:143], a[80:83], v[14:17], v[128:143]
    ds_read_b128 a[88:91], v4
    ds_read_b64_tr_b16 v[6:7], v18 offset:6144
    ds_read_b64_tr_b16 v[8:9], v18 offset:6912
    buffer_load_dwordx4 v38, s[12:15], s35 offen offset:0 lds
    s_waitcnt lgkmcnt(10)
    v_mfma_f32_32x32x16_bf16 v[144:159], a[80:83], v[26:29], v[144:159]
    ds_read_b64_tr_b16 v[14:15], v18 offset:6208
    ds_read_b64_tr_b16 v[16:17], v18 offset:6976
    s_waitcnt lgkmcnt(9)
    v_mfma_f32_32x32x16_bf16 v[112:127], a[84:87], v[30:33], v[112:127]
    ds_read_b64_tr_b16 v[26:27], v18 offset:6272
    ds_read_b64_tr_b16 v[28:29], v18 offset:7040
    buffer_load_dwordx4 v39, s[12:15], s35 offen offset:1024 lds
    s_waitcnt lgkmcnt(9)
    v_mfma_f32_32x32x16_bf16 v[128:143], a[84:87], v[34:37], v[128:143]
    ds_read_b128 a[92:95], v5
    ds_read_b64_tr_b16 v[30:31], v18 offset:9216
    ds_read_b64_tr_b16 v[32:33], v18 offset:9984
    s_waitcnt lgkmcnt(10)
    v_mfma_f32_32x32x16_bf16 v[144:159], a[84:87], v[52:55], v[144:159]
    ds_read_b64_tr_b16 v[34:35], v18 offset:9280
    ds_read_b64_tr_b16 v[36:37], v18 offset:10048
    buffer_load_dwordx4 v57, s[12:15], s35 offen offset:2048 lds
    s_waitcnt lgkmcnt(9)
    v_mfma_f32_32x32x16_bf16 v[112:127], a[88:91], v[6:9], v[112:127]
    ds_read_b64_tr_b16 v[52:53], v18 offset:9344
    ds_read_b64_tr_b16 v[54:55], v18 offset:10112
    s_waitcnt lgkmcnt(9)
    v_mfma_f32_32x32x16_bf16 v[128:143], a[88:91], v[14:17], v[128:143]
    s_waitcnt vmcnt(17)
    s_barrier
    s_waitcnt lgkmcnt(0)
    s_branch L_chk
L_chk_ok:
    ds_read_b128 a[96:99], v2 offset:32768
    ds_read_b64_tr_b16 v[6:7], v18 offset:32768
    ds_read_b64_tr_b16 v[8:9], v18 offset:33536
    s_bfe_u32 s66, s6, 0x30001
    s_lshr_b64 s[6:7], s[6:7], 8
    s_lshl_b32 s66, s66, 11
    s_add_u32 s66, s66, s45
    buffer_load_dwordx4 v[232:235], v44, s[16:19], s66 offen sc1
    buffer_load_dwordx4 v[236:239], v44, s[16:19], s66 offen offset:1024 sc1
    s_bfe_u32 s66, s6, 0x30001
    s_lshr_b64 s[6:7], s[6:7], 8
    s_lshl_b32 s66, s66, 11
    s_add_u32 s66, s66, s45
    v_mfma_f32_32x32x16_bf16 v[144:159], a[88:91], v[26:29], v[144:159]
    ds_read_b64_tr_b16 v[14:15], v18 offset:32832
    ds_read_b64_tr_b16 v[16:17], v18 offset:33600
    buffer_load_dwordx4 v[240:243], v44, s[16:19], s66 offen sc1
    v_mfma_f32_32x32x16_bf16 v[112:127], a[92:95], v[30:33], v[112:127]
    ds_read_b64_tr_b16 v[26:27], v18 offset:32896
    ds_read_b64_tr_b16 v[28:29], v18 offset:33664
    buffer_load_dwordx4 v[244:247], v44, s[16:19], s66 offen offset:1024 sc1
    s_bfe_u32 s66, s6, 0x30001
    s_lshr_b64 s[6:7], s[6:7], 8
    s_lshl_b32 s66, s66, 11
    s_add_u32 s66, s66, s45
    v_mfma_f32_32x32x16_bf16 v[128:143], a[92:95], v[34:37], v[128:143]
    ds_read_b128 a[100:103], v3 offset:32768
    ds_read_b64_tr_b16 v[30:31], v18 offset:35840
    ds_read_b64_tr_b16 v[32:33], v18 offset:36608
    buffer_load_dwordx4 v[248:251], v44, s[16:19], s66 offen sc1
    v_mfma_f32_32x32x16_bf16 v[144:159], a[92:95], v[52:55], v[144:159]
    ds_read_b64_tr_b16 v[34:35], v18 offset:35904
    ds_read_b64_tr_b16 v[36:37], v18 offset:36672
    buffer_load_dwordx4 v[252:255], v44, s[16:19], s66 offen offset:1024 sc1
    s_and_b32 s35, s36, 15
    s_lshr_b64 s[36:37], s[36:37], 4
    s_lshr_b32 s67, s35, 1
    s_lshl_b32 s34, s35, 7
    s_mul_i32 s67, s67, s39
    s_lshl_b32 s35, s35, s38
    s_add_u32 s34, s34, s67
    s_add_u32 m0, s41, 131072
    s_waitcnt lgkmcnt(9)
    v_mfma_f32_32x32x16_bf16 v[64:79], a[96:99], v[6:9], 0
    ds_read_b64_tr_b16 v[52:53], v18 offset:35968
    ds_read_b64_tr_b16 v[54:55], v18 offset:36736
    buffer_load_dwordx4 v22, s[8:11], s34 offen offset:0 lds
    s_nop 3
    v_cvt_pk_bf16_f32 v208, v112, v113
    v_cvt_pk_bf16_f32 v209, v114, v115
    s_waitcnt lgkmcnt(9)
    v_mfma_f32_32x32x16_bf16 v[80:95], a[96:99], v[14:17], 0
    ds_read_b128 a[104:107], v4 offset:32768
    ds_read_b64_tr_b16 v[6:7], v18 offset:38912
    ds_read_b64_tr_b16 v[8:9], v18 offset:39680
    buffer_load_dwordx4 v23, s[8:11], s34 offen offset:1024 lds
    v_cvt_pk_bf16_f32 v210, v116, v117
    v_cvt_pk_bf16_f32 v211, v118, v119
    v_cvt_pk_bf16_f32 v212, v120, v121
    s_waitcnt lgkmcnt(10)
    v_mfma_f32_32x32x16_bf16 v[96:111], a[96:99], v[26:29], 0
    ds_read_b64_tr_b16 v[14:15], v18 offset:38976
    ds_read_b64_tr_b16 v[16:17], v18 offset:39744
    buffer_load_dwordx4 v24, s[8:11], s34 offen offset:2048 lds
    v_cvt_pk_bf16_f32 v213, v122, v123
    v_cvt_pk_bf16_f32 v214, v124, v125
    v_cvt_pk_bf16_f32 v215, v126, v127
    s_waitcnt lgkmcnt(9)
    v_mfma_f32_32x32x16_bf16 v[64:79], a[100:103], v[30:33], v[64:79]
    ds_read_b64_tr_b16 v[26:27], v18 offset:39040
    ds_read_b64_tr_b16 v[28:29], v18 offset:39808
    buffer_load_dwordx4 v25, s[8:11], s34 offen offset:3072 lds
    s_add_u32 m0, s42, 131072
    v_cvt_pk_bf16_f32 v216, v128, v129
    v_cvt_pk_bf16_f32 v217, v130, v131
    v_cvt_pk_bf16_f32 v218, v132, v133
    s_waitcnt lgkmcnt(9)
    v_mfma_f32_32x32x16_bf16 v[80:95], a[100:103], v[34:37], v[80:95]
    ds_read_b128 a[108:111], v5 offset:32768
    ds_read_b64_tr_b16 v[30:31], v18 offset:41984
    ds_read_b64_tr_b16 v[32:33], v18 offset:42752
    buffer_load_dwordx4 v38, s[12:15], s35 offen offset:0 lds
    v_cvt_pk_bf16_f32 v219, v134, v135
    v_cvt_pk_bf16_f32 v220, v136, v137
    v_cvt_pk_bf16_f32 v221, v138, v139
    s_waitcnt lgkmcnt(10)
    v_mfma_f32_32x32x16_bf16 v[96:111], a[100:103], v[52:55], v[96:111]
    ds_read_b64_tr_b16 v[34:35], v18 offset:42048
    ds_read_b64_tr_b16 v[36:37], v18 offset:42816
    buffer_load_dwordx4 v39, s[12:15], s35 offen offset:1024 lds
    v_cvt_pk_bf16_f32 v222, v140, v141
    v_cvt_pk_bf16_f32 v223, v142, v143
    v_cvt_pk_bf16_f32 v224, v144, v145
    s_waitcnt lgkmcnt(9)
    v_mfma_f32_32x32x16_bf16 v[64:79], a[104:107], v[6:9], v[64:79]
    ds_read_b64_tr_b16 v[52:53], v18 offset:42112
    ds_read_b64_tr_b16 v[54:55], v18 offset:42880
    buffer_load_dwordx4 v57, s[12:15], s35 offen offset:2048 lds
    v_cvt_pk_bf16_f32 v225, v146, v147
    v_cvt_pk_bf16_f32 v226, v148, v149
    v_cvt_pk_bf16_f32 v227, v150, v151
    s_waitcnt lgkmcnt(9)
    v_mfma_f32_32x32x16_bf16 v[80:95], a[104:107], v[14:17], v[80:95]
    s_waitcnt vmcnt(20)
    s_barrier
    ds_read_b128 a[112:115], v10
    ds_read_b64_tr_b16 v[6:7], v19 offset:0
    ds_read_b64_tr_b16 v[8:9], v19 offset:768
    s_and_b32 s35, s36, 15
    s_lshr_b64 s[36:37], s[36:37], 4
    s_lshr_b32 s67, s35, 1
    s_lshl_b32 s34, s35, 7
    s_mul_i32 s67, s67, s39
    s_lshl_b32 s35, s35, s38
    s_add_u32 s34, s34, s67
    s_add_u32 m0, s41, 0
    s_nop 0
    buffer_load_dwordx4 v22, s[8:11], s34 offen offset:0 lds
    v_cvt_pk_bf16_f32 v228, v152, v153
    v_cvt_pk_bf16_f32 v229, v154, v155
    v_cvt_pk_bf16_f32 v230, v156, v157
    s_waitcnt lgkmcnt(10)
    v_mfma_f32_32x32x16_bf16 v[96:111], a[104:107], v[26:29], v[96:111]
    ds_read_b64_tr_b16 v[14:15], v19 offset:64
    ds_read_b64_tr_b16 v[16:17], v19 offset:832
    buffer_load_dwordx4 v23, s[8:11], s34 offen offset:1024 lds
    v_cvt_pk_bf16_f32 v231, v158, v159
    s_waitcnt lgkmcnt(9)
    v_mfma_f32_32x32x16_bf16 v[64:79], a[108:111], v[30:33], v[64:79]
    ds_read_b64_tr_b16 v[26:27], v19 offset:128
    ds_read_b64_tr_b16 v[28:29], v19 offset:896
    s_waitcnt lgkmcnt(9)
    v_mfma_f32_32x32x16_bf16 v[80:95], a[108:111], v[34:37], v[80:95]
    ds_read_b128 a[116:119], v11
    ds_read_b64_tr_b16 v[30:31], v19 offset:3072
    ds_read_b64_tr_b16 v[32:33], v19 offset:3840
    buffer_load_dwordx4 v24, s[8:11], s34 offen offset:2048 lds
    s_waitcnt lgkmcnt(10)
    v_mfma_f32_32x32x16_bf16 v[96:111], a[108:111], v[52:55], v[96:111]
    ds_read_b64_tr_b16 v[34:35], v19 offset:3136
    ds_read_b64_tr_b16 v[36:37], v19 offset:3904
    s_waitcnt lgkmcnt(9)
    v_mfma_f32_32x32x16_bf16 v[64:79], a[112:115], v[6:9], v[64:79]
    ds_read_b64_tr_b16 v[52:53], v19 offset:3200
    ds_read_b64_tr_b16 v[54:55], v19 offset:3968
    buffer_load_dwordx4 v25, s[8:11], s34 offen offset:3072 lds
    s_add_u32 m0, s42, 0
    s_waitcnt lgkmcnt(9)
    v_mfma_f32_32x32x16_bf16 v[80:95], a[112:115], v[14:17], v[80:95]
    ds_read_b128 a[120:123], v12
    ds_read_b64_tr_b16 v[6:7], v19 offset:6144
    ds_read_b64_tr_b16 v[8:9], v19 offset:6912
    buffer_load_dwordx4 v38, s[12:15], s35 offen offset:0 lds
    s_waitcnt lgkmcnt(10)
    v_mfma_f32_32x32x16_bf16 v[96:111], a[112:115], v[26:29], v[96:111]
    ds_read_b64_tr_b16 v[14:15], v19 offset:6208
    ds_read_b64_tr_b16 v[16:17], v19 offset:6976
    s_waitcnt lgkmcnt(9)
    v_mfma_f32_32x32x16_bf16 v[64:79], a[116:119], v[30:33], v[64:79]
    ds_read_b64_tr_b16 v[26:27], v19 offset:6272
    ds_read_b64_tr_b16 v[28:29], v19 offset:7040
    buffer_load_dwordx4 v39, s[12:15], s35 offen offset:1024 lds
    s_waitcnt lgkmcnt(9)
    v_mfma_f32_32x32x16_bf16 v[80:95], a[116:119], v[34:37], v[80:95]
    ds_read_b128 a[124:127], v13
    ds_read_b64_tr_b16 v[30:31], v19 offset:9216
    ds_read_b64_tr_b16 v[32:33], v19 offset:9984
    s_waitcnt lgkmcnt(10)
    v_mfma_f32_32x32x16_bf16 v[96:111], a[116:119], v[52:55], v[96:111]
    ds_read_b64_tr_b16 v[34:35], v19 offset:9280
    ds_read_b64_tr_b16 v[36:37], v19 offset:10048
    buffer_load_dwordx4 v57, s[12:15], s35 offen offset:2048 lds
    s_waitcnt lgkmcnt(9)
    v_mfma_f32_32x32x16_bf16 v[64:79], a[120:123], v[6:9], v[64:79]
    ds_read_b64_tr_b16 v[52:53], v19 offset:9344
    ds_read_b64_tr_b16 v[54:55], v19 offset:10112
    s_waitcnt lgkmcnt(9)
    v_mfma_f32_32x32x16_bf16 v[80:95], a[120:123], v[14:17], v[80:95]
    s_waitcnt vmcnt(20)
    s_barrier
    ds_read_b128 a[128:131], v10 offset:32768
    ds_read_b64_tr_b16 v[6:7], v19 offset:32768
    ds_read_b64_tr_b16 v[8:9], v19 offset:33536
    s_and_b32 s35, s36, 15
    s_lshr_b64 s[36:37], s[36:37], 4
    s_lshr_b32 s67, s35, 1
    s_lshl_b32 s34, s35, 7
    s_mul_i32 s67, s67, s39
    s_lshl_b32 s35, s35, s38
    s_add_u32 s34, s34, s67
    s_add_u32 m0, s41, 32768
    s_nop 0
    buffer_load_dwordx4 v22, s[8:11], s34 offen offset:0 lds
    s_waitcnt lgkmcnt(10)
    v_mfma_f32_32x32x16_bf16 v[96:111], a[120:123], v[26:29], v[96:111]
    ds_read_b64_tr_b16 v[14:15], v19 offset:32832
    ds_read_b64_tr_b16 v[16:17], v19 offset:33600
    buffer_load_dwordx4 v23, s[8:11], s34 offen offset:1024 lds
    s_waitcnt lgkmcnt(9)
    v_mfma_f32_32x32x16_bf16 v[64:79], a[124:127], v[30:33], v[64:79]
    ds_read_b64_tr_b16 v[26:27], v19 offset:32896
    ds_read_b64_tr_b16 v[28:29], v19 offset:33664
    s_waitcnt lgkmcnt(9)
    v_mfma_f32_32x32x16_bf16 v[80:95], a[124:127], v[34:37], v[80:95]
    ds_read_b128 a[132:135], v11 offset:32768
    ds_read_b64_tr_b16 v[30:31], v19 offset:35840
    ds_read_b64_tr_b16 v[32:33], v19 offset:36608
    buffer_load_dwordx4 v24, s[8:11], s34 offen offset:2048 lds
    s_waitcnt lgkmcnt(10)
    v_mfma_f32_32x32x16_bf16 v[96:111], a[124:127], v[52:55], v[96:111]
    ds_read_b64_tr_b16 v[34:35], v19 offset:35904
    ds_read_b64_tr_b16 v[36:37], v19 offset:36672
    s_waitcnt vmcnt(17)
    v_mfma_f32_32x32x16_bf16 v[112:127], v[160:163], v[232:235], 0
    v_mfma_f32_32x32x16_bf16 v[112:127], v[164:167], v[236:239], v[112:127]
    v_mfma_f32_32x32x16_bf16 v[128:143], v[168:171], v[232:235], 0
    v_mfma_f32_32x32x16_bf16 v[128:143], v[172:175], v[236:239], v[128:143]
    v_mfma_f32_32x32x16_bf16 v[144:159], v[176:179], v[232:235], 0
    v_mfma_f32_32x32x16_bf16 v[144:159], v[180:183], v[236:239], v[144:159]
    v_mfma_f32_32x32x16_bf16 v[112:127], v[184:187], v[240:243], v[112:127]
    v_cvt_pk_bf16_f32 v160, v64, v65
    v_cvt_pk_bf16_f32 v161, v66, v67
    v_cvt_pk_bf16_f32 v162, v68, v69
    v_cvt_pk_bf16_f32 v163, v70, v71
    v_mfma_f32_32x32x16_bf16 v[112:127], v[188:191], v[244:247], v[112:127]
    v_cvt_pk_bf16_f32 v164, v72, v73
    v_cvt_pk_bf16_f32 v165, v74, v75
    v_cvt_pk_bf16_f32 v166, v76, v77
    v_cvt_pk_bf16_f32 v167, v78, v79
    v_mfma_f32_32x32x16_bf16 v[128:143], v[192:195], v[240:243], v[128:143]
    v_cvt_pk_bf16_f32 v168, v80, v81
    v_cvt_pk_bf16_f32 v169, v82, v83
    v_cvt_pk_bf16_f32 v170, v84, v85
    v_cvt_pk_bf16_f32 v171, v86, v87
    v_mfma_f32_32x32x16_bf16 v[128:143], v[196:199], v[244:247], v[128:143]
    v_cvt_pk_bf16_f32 v172, v88, v89
    v_cvt_pk_bf16_f32 v173, v90, v91
    v_cvt_pk_bf16_f32 v174, v92, v93
    v_cvt_pk_bf16_f32 v175, v94, v95
    v_mfma_f32_32x32x16_bf16 v[144:159], v[200:203], v[240:243], v[144:159]
    v_cvt_pk_bf16_f32 v176, v96, v97
    v_cvt_pk_bf16_f32 v177, v98, v99
    v_cvt_pk_bf16_f32 v178, v100, v101
    v_cvt_pk_bf16_f32 v179, v102, v103
    v_mfma_f32_32x32x16_bf16 v[144:159], v[204:207], v[244:247], v[144:159]
    v_cvt_pk_bf16_f32 v180, v104, v105
    v_cvt_pk_bf16_f32 v181, v106, v107
    v_cvt_pk_bf16_f32 v182, v108, v109
    v_cvt_pk_bf16_f32 v183, v110, v111
    v_mfma_f32_32x32x16_bf16 v[112:127], v[208:211], v[248:251], v[112:127]
    v_mfma_f32_32x32x16_bf16 v[112:127], v[212:215], v[252:255], v[112:127]
    v_mfma_f32_32x32x16_bf16 v[128:143], v[216:219], v[248:251], v[128:143]
    v_mfma_f32_32x32x16_bf16 v[128:143], v[220:223], v[252:255], v[128:143]
    v_mfma_f32_32x32x16_bf16 v[144:159], v[224:227], v[248:251], v[144:159]
    v_mfma_f32_32x32x16_bf16 v[144:159], v[228:231], v[252:255], v[144:159]
    s_waitcnt lgkmcnt(9)
    v_mfma_f32_32x32x16_bf16 v[64:79], a[128:131], v[6:9], 0
    ds_read_b64_tr_b16 v[52:53], v19 offset:35968
    ds_read_b64_tr_b16 v[54:55], v19 offset:36736
    buffer_load_dwordx4 v25, s[8:11], s34 offen offset:3072 lds
    s_add_u32 m0, s42, 32768
    s_waitcnt lgkmcnt(9)
    v_mfma_f32_32x32x16_bf16 v[80:95], a[128:131], v[14:17], 0
    ds_read_b128 a[136:139], v12 offset:32768
    ds_read_b64_tr_b16 v[6:7], v19 offset:38912
    ds_read_b64_tr_b16 v[8:9], v19 offset:39680
    buffer_load_dwordx4 v38, s[12:15], s35 offen offset:0 lds
    s_waitcnt lgkmcnt(10)
    v_mfma_f32_32x32x16_bf16 v[96:111], a[128:131], v[26:29], 0
    ds_read_b64_tr_b16 v[14:15], v19 offset:38976
    ds_read_b64_tr_b16 v[16:17], v19 offset:39744
    s_waitcnt lgkmcnt(9)
    v_mfma_f32_32x32x16_bf16 v[64:79], a[132:135], v[30:33], v[64:79]
    ds_read_b64_tr_b16 v[26:27], v19 offset:39040
    ds_read_b64_tr_b16 v[28:29], v19 offset:39808
    buffer_load_dwordx4 v39, s[12:15], s35 offen offset:1024 lds
    s_waitcnt lgkmcnt(9)
    v_mfma_f32_32x32x16_bf16 v[80:95], a[132:135], v[34:37], v[80:95]
    ds_read_b128 a[140:143], v13 offset:32768
    ds_read_b64_tr_b16 v[30:31], v19 offset:41984
    ds_read_b64_tr_b16 v[32:33], v19 offset:42752
    s_waitcnt lgkmcnt(10)
    v_mfma_f32_32x32x16_bf16 v[96:111], a[132:135], v[52:55], v[96:111]
    ds_read_b64_tr_b16 v[34:35], v19 offset:42048
    ds_read_b64_tr_b16 v[36:37], v19 offset:42816
    buffer_load_dwordx4 v57, s[12:15], s35 offen offset:2048 lds
    s_waitcnt lgkmcnt(9)
    v_mfma_f32_32x32x16_bf16 v[64:79], a[136:139], v[6:9], v[64:79]
    ds_read_b64_tr_b16 v[52:53], v19 offset:42112
    ds_read_b64_tr_b16 v[54:55], v19 offset:42880
    s_waitcnt lgkmcnt(9)
    v_mfma_f32_32x32x16_bf16 v[80:95], a[136:139], v[14:17], v[80:95]
    s_waitcnt vmcnt(14)
    s_barrier
    ds_read_b128 a[144:147], v40
    ds_read_b64_tr_b16 v[6:7], v20 offset:0
    ds_read_b64_tr_b16 v[8:9], v20 offset:768
    s_bfe_u32 s66, s6, 0x30001
    s_lshr_b64 s[6:7], s[6:7], 8
    s_lshl_b32 s66, s66, 11
    s_add_u32 s66, s66, s45
    buffer_load_dwordx4 v[184:187], v44, s[16:19], s66 offen sc1
    buffer_load_dwordx4 v[188:191], v44, s[16:19], s66 offen offset:1024 sc1
    s_bfe_u32 s66, s6, 0x30001
    s_lshr_b64 s[6:7], s[6:7], 8
    s_lshl_b32 s66, s66, 11
    s_add_u32 s66, s66, s45
    s_waitcnt lgkmcnt(10)
    v_mfma_f32_32x32x16_bf16 v[96:111], a[136:139], v[26:29], v[96:111]
    ds_read_b64_tr_b16 v[14:15], v20 offset:64
    ds_read_b64_tr_b16 v[16:17], v20 offset:832
    buffer_load_dwordx4 v[192:195], v44, s[16:19], s66 offen sc1
    s_waitcnt lgkmcnt(9)
    v_mfma_f32_32x32x16_bf16 v[64:79], a[140:143], v[30:33], v[64:79]
    ds_read_b64_tr_b16 v[26:27], v20 offset:128
    ds_read_b64_tr_b16 v[28:29], v20 offset:896
    buffer_load_dwordx4 v[196:199], v44, s[16:19], s66 offen offset:1024 sc1
    s_bfe_u32 s66, s6, 0x30001
    s_lshr_b64 s[6:7], s[6:7], 8
    s_lshl_b32 s66, s66, 11
    s_add_u32 s66, s66, s45
    buffer_load_dwordx4 v[200:203], v44, s[16:19], s66 offen sc1
    s_waitcnt lgkmcnt(9)
    v_mfma_f32_32x32x16_bf16 v[80:95], a[140:143], v[34:37], v[80:95]
    ds_read_b128 a[148:151], v41
    ds_read_b64_tr_b16 v[30:31], v20 offset:3072
    ds_read_b64_tr_b16 v[32:33], v20 offset:3840
    buffer_load_dwordx4 v[204:207], v44, s[16:19], s66 offen offset:1024 sc1
    s_bfe_u32 s66, s6, 0x30001
    s_lshr_b64 s[6:7], s[6:7], 8
    s_lshl_b32 s66, s66, 11
    s_add_u32 s66, s66, s45
    s_waitcnt lgkmcnt(10)
    v_mfma_f32_32x32x16_bf16 v[96:111], a[140:143], v[52:55], v[96:111]
    ds_read_b64_tr_b16 v[34:35], v20 offset:3136
    ds_read_b64_tr_b16 v[36:37], v20 offset:3904
    buffer_load_dwordx4 v[208:211], v44, s[16:19], s66 offen sc1
    buffer_load_dwordx4 v[212:215], v44, s[16:19], s66 offen offset:1024 sc1
    s_bfe_u32 s66, s6, 0x30001
    s_lshr_b64 s[6:7], s[6:7], 8
    s_lshl_b32 s66, s66, 11
    s_add_u32 s66, s66, s45
    s_waitcnt lgkmcnt(9)
    v_mfma_f32_32x32x16_bf16 v[64:79], a[144:147], v[6:9], v[64:79]
    ds_read_b64_tr_b16 v[52:53], v20 offset:3200
    ds_read_b64_tr_b16 v[54:55], v20 offset:3968
    buffer_load_dwordx4 v[216:219], v44, s[16:19], s66 offen sc1
    s_waitcnt lgkmcnt(9)
    v_mfma_f32_32x32x16_bf16 v[80:95], a[144:147], v[14:17], v[80:95]
    ds_read_b128 a[152:155], v42
    ds_read_b64_tr_b16 v[6:7], v20 offset:6144
    ds_read_b64_tr_b16 v[8:9], v20 offset:6912
    buffer_load_dwordx4 v[220:223], v44, s[16:19], s66 offen offset:1024 sc1
    s_and_b32 s35, s36, 15
    s_lshr_b64 s[36:37], s[36:37], 4
    s_lshr_b32 s67, s35, 1
    s_lshl_b32 s34, s35, 7
    s_mul_i32 s67, s67, s39
    s_lshl_b32 s35, s35, s38
    s_add_u32 s34, s34, s67
    s_add_u32 m0, s41, 65536
    s_waitcnt lgkmcnt(10)
    v_mfma_f32_32x32x16_bf16 v[96:111], a[144:147], v[26:29], v[96:111]
    ds_read_b64_tr_b16 v[14:15], v20 offset:6208
    ds_read_b64_tr_b16 v[16:17], v20 offset:6976
    buffer_load_dwordx4 v22, s[8:11], s34 offen offset:0 lds
    buffer_load_dwordx4 v23, s[8:11], s34 offen offset:1024 lds
    s_waitcnt lgkmcnt(9)
    v_mfma_f32_32x32x16_bf16 v[64:79], a[148:151], v[30:33], v[64:79]
    ds_read_b64_tr_b16 v[26:27], v20 offset:6272
    ds_read_b64_tr_b16 v[28:29], v20 offset:7040
    buffer_load_dwordx4 v24, s[8:11], s34 offen offset:2048 lds
    s_waitcnt lgkmcnt(9)
    v_mfma_f32_32x32x16_bf16 v[80:95], a[148:151], v[34:37], v[80:95]
    ds_read_b128 a[156:159], v43
    ds_read_b64_tr_b16 v[30:31], v20 offset:9216
    ds_read_b64_tr_b16 v[32:33], v20 offset:9984
    buffer_load_dwordx4 v25, s[8:11], s34 offen offset:3072 lds
    s_add_u32 m0, s42, 65536
    s_nop 0
    buffer_load_dwordx4 v38, s[12:15], s35 offen offset:0 lds
    s_waitcnt lgkmcnt(10)
    v_mfma_f32_32x32x16_bf16 v[96:111], a[148:151], v[52:55], v[96:111]
    ds_read_b64_tr_b16 v[34:35], v20 offset:9280
    ds_read_b64_tr_b16 v[36:37], v20 offset:10048
    buffer_load_dwordx4 v39, s[12:15], s35 offen offset:1024 lds
    s_waitcnt lgkmcnt(9)
    v_mfma_f32_32x32x16_bf16 v[64:79], a[152:155], v[6:9], v[64:79]
    ds_read_b64_tr_b16 v[52:53], v20 offset:9344
    ds_read_b64_tr_b16 v[54:55], v20 offset:10112
    buffer_load_dwordx4 v57, s[12:15], s35 offen offset:2048 lds
    s_waitcnt lgkmcnt(9)
    v_mfma_f32_32x32x16_bf16 v[80:95], a[152:155], v[14:17], v[80:95]
    s_waitcnt vmcnt(24)
    s_barrier
    ds_read_b128 a[160:163], v2
    ds_read_b64_tr_b16 v[6:7], v18 offset:0
    ds_read_b64_tr_b16 v[8:9], v18 offset:768
    s_and_b32 s35, s36, 15
    s_lshr_b64 s[36:37], s[36:37], 4
    s_lshr_b32 s67, s35, 1
    s_lshl_b32 s34, s35, 7
    s_mul_i32 s67, s67, s39
    s_lshl_b32 s35, s35, s38
    s_add_u32 s34, s34, s67
    s_add_u32 m0, s41, 98304
    s_nop 0
    buffer_load_dwordx4 v22, s[8:11], s34 offen offset:0 lds
    s_waitcnt lgkmcnt(10)
    v_mfma_f32_32x32x16_bf16 v[96:111], a[152:155], v[26:29], v[96:111]
    ds_read_b64_tr_b16 v[14:15], v18 offset:64
    ds_read_b64_tr_b16 v[16:17], v18 offset:832
    buffer_load_dwordx4 v23, s[8:11], s34 offen offset:1024 lds
    s_waitcnt lgkmcnt(9)
    v_mfma_f32_32x32x16_bf16 v[64:79], a[156:159], v[30:33], v[64:79]
    ds_read_b64_tr_b16 v[26:27], v18 offset:128
    ds_read_b64_tr_b16 v[28:29], v18 offset:896
    s_waitcnt lgkmcnt(9)
    v_mfma_f32_32x32x16_bf16 v[80:95], a[156:159], v[34:37], v[80:95]
    ds_read_b128 a[164:167], v3
    ds_read_b64_tr_b16 v[30:31], v18 offset:3072
    ds_read_b64_tr_b16 v[32:33], v18 offset:3840
    buffer_load_dwordx4 v24, s[8:11], s34 offen offset:2048 lds
    s_waitcnt lgkmcnt(10)
    v_mfma_f32_32x32x16_bf16 v[96:111], a[156:159], v[52:55], v[96:111]
    ds_read_b64_tr_b16 v[34:35], v18 offset:3136
    ds_read_b64_tr_b16 v[36:37], v18 offset:3904
    s_waitcnt vmcnt(18)
    v_mfma_f32_32x32x16_bf16 v[112:127], v[160:163], v[184:187], v[112:127]
    v_mfma_f32_32x32x16_bf16 v[112:127], v[164:167], v[188:191], v[112:127]
    s_nop 1
    v_mfma_f32_32x32x16_bf16 v[128:143], v[168:171], v[184:187], v[128:143]
    v_cvt_pk_bf16_f32 v160, v64, v65
    v_cvt_pk_bf16_f32 v161, v66, v67
    v_cvt_pk_bf16_f32 v162, v68, v69
    v_cvt_pk_bf16_f32 v163, v70, v71
    v_mfma_f32_32x32x16_bf16 v[128:143], v[172:175], v[188:191], v[128:143]
    v_cvt_pk_bf16_f32 v164, v72, v73
    v_cvt_pk_bf16_f32 v165, v74, v75
    v_cvt_pk_bf16_f32 v166, v76, v77
    v_cvt_pk_bf16_f32 v167, v78, v79
    v_mfma_f32_32x32x16_bf16 v[144:159], v[176:179], v[184:187], v[144:159]
    v_cvt_pk_bf16_f32 v168, v80, v81
    v_cvt_pk_bf16_f32 v169, v82, v83
    v_cvt_pk_bf16_f32 v170, v84, v85
    v_cvt_pk_bf16_f32 v171, v86, v87
    v_mfma_f32_32x32x16_bf16 v[144:159], v[180:183], v[188:191], v[144:159]
    v_cvt_pk_bf16_f32 v172, v88, v89
    v_cvt_pk_bf16_f32 v173, v90, v91
    v_cvt_pk_bf16_f32 v174, v92, v93
    v_cvt_pk_bf16_f32 v175, v94, v95
    s_waitcnt lgkmcnt(9)
    v_mfma_f32_32x32x16_bf16 v[64:79], a[160:163], v[6:9], 0
    ds_read_b64_tr_b16 v[52:53], v18 offset:3200
    ds_read_b64_tr_b16 v[54:55], v18 offset:3968
    buffer_load_dwordx4 v25, s[8:11], s34 offen offset:3072 lds
    s_add_u32 m0, s42, 98304
    v_cvt_pk_bf16_f32 v176, v96, v97
    v_cvt_pk_bf16_f32 v177, v98, v99
    v_cvt_pk_bf16_f32 v178, v100, v101
    v_cvt_pk_bf16_f32 v179, v102, v103
    s_waitcnt lgkmcnt(9)
    v_mfma_f32_32x32x16_bf16 v[80:95], a[160:163], v[14:17], 0
    ds_read_b128 a[168:171], v4
    ds_read_b64_tr_b16 v[6:7], v18 offset:6144
    ds_read_b64_tr_b16 v[8:9], v18 offset:6912
    buffer_load_dwordx4 v38, s[12:15], s35 offen offset:0 lds
    v_cvt_pk_bf16_f32 v180, v104, v105
    v_cvt_pk_bf16_f32 v181, v106, v107
    v_cvt_pk_bf16_f32 v182, v108, v109
    v_cvt_pk_bf16_f32 v183, v110, v111
    s_waitcnt lgkmcnt(10)
    v_mfma_f32_32x32x16_bf16 v[96:111], a[160:163], v[26:29], 0
    ds_read_b64_tr_b16 v[14:15], v18 offset:6208
    ds_read_b64_tr_b16 v[16:17], v18 offset:6976
    s_waitcnt lgkmcnt(9)
    v_mfma_f32_32x32x16_bf16 v[64:79], a[164:167], v[30:33], v[64:79]
    ds_read_b64_tr_b16 v[26:27], v18 offset:6272
    ds_read_b64_tr_b16 v[28:29], v18 offset:7040
    buffer_load_dwordx4 v39, s[12:15], s35 offen offset:1024 lds
    s_waitcnt lgkmcnt(9)
    v_mfma_f32_32x32x16_bf16 v[80:95], a[164:167], v[34:37], v[80:95]
    ds_read_b128 a[172:175], v5
    ds_read_b64_tr_b16 v[30:31], v18 offset:9216
    ds_read_b64_tr_b16 v[32:33], v18 offset:9984
    s_waitcnt lgkmcnt(10)
    v_mfma_f32_32x32x16_bf16 v[96:111], a[164:167], v[52:55], v[96:111]
    ds_read_b64_tr_b16 v[34:35], v18 offset:9280
    ds_read_b64_tr_b16 v[36:37], v18 offset:10048
    buffer_load_dwordx4 v57, s[12:15], s35 offen offset:2048 lds
    s_waitcnt lgkmcnt(9)
    v_mfma_f32_32x32x16_bf16 v[64:79], a[168:171], v[6:9], v[64:79]
    ds_read_b64_tr_b16 v[52:53], v18 offset:9344
    ds_read_b64_tr_b16 v[54:55], v18 offset:10112
    s_waitcnt lgkmcnt(9)
    v_mfma_f32_32x32x16_bf16 v[80:95], a[168:171], v[14:17], v[80:95]
    s_barrier
    ds_read_b128 a[176:179], v2 offset:32768
    ds_read_b64_tr_b16 v[6:7], v18 offset:32768
    ds_read_b64_tr_b16 v[8:9], v18 offset:33536
    s_and_b32 s35, s36, 15
    s_lshr_b64 s[36:37], s[36:37], 4
    s_lshr_b32 s67, s35, 1
    s_lshl_b32 s34, s35, 7
    s_mul_i32 s67, s67, s39
    s_lshl_b32 s35, s35, s38
    s_add_u32 s34, s34, s67
    s_add_u32 m0, s41, 131072
    s_nop 0
    buffer_load_dwordx4 v22, s[8:11], s34 offen offset:0 lds
    s_waitcnt lgkmcnt(10)
    v_mfma_f32_32x32x16_bf16 v[96:111], a[168:171], v[26:29], v[96:111]
    ds_read_b64_tr_b16 v[14:15], v18 offset:32832
    ds_read_b64_tr_b16 v[16:17], v18 offset:33600
    buffer_load_dwordx4 v23, s[8:11], s34 offen offset:1024 lds
    s_waitcnt lgkmcnt(9)
    v_mfma_f32_32x32x16_bf16 v[64:79], a[172:175], v[30:33], v[64:79]
    ds_read_b64_tr_b16 v[26:27], v18 offset:32896
    ds_read_b64_tr_b16 v[28:29], v18 offset:33664
    s_waitcnt lgkmcnt(9)
    v_mfma_f32_32x32x16_bf16 v[80:95], a[172:175], v[34:37], v[80:95]
    ds_read_b128 a[180:183], v3 offset:32768
    ds_read_b64_tr_b16 v[30:31], v18 offset:35840
    ds_read_b64_tr_b16 v[32:33], v18 offset:36608
    buffer_load_dwordx4 v24, s[8:11], s34 offen offset:2048 lds
    s_waitcnt lgkmcnt(10)
    v_mfma_f32_32x32x16_bf16 v[96:111], a[172:175], v[52:55], v[96:111]
    ds_read_b64_tr_b16 v[34:35], v18 offset:35904
    ds_read_b64_tr_b16 v[36:37], v18 offset:36672
    s_waitcnt lgkmcnt(9)
    v_mfma_f32_32x32x16_bf16 v[64:79], a[176:179], v[6:9], v[64:79]
    ds_read_b64_tr_b16 v[52:53], v18 offset:35968
    ds_read_b64_tr_b16 v[54:55], v18 offset:36736
    buffer_load_dwordx4 v25, s[8:11], s34 offen offset:3072 lds
    s_add_u32 m0, s42, 131072
    s_waitcnt lgkmcnt(9)
    v_mfma_f32_32x32x16_bf16 v[80:95], a[176:179], v[14:17], v[80:95]
    ds_read_b128 a[184:187], v4 offset:32768
    ds_read_b64_tr_b16 v[6:7], v18 offset:38912
    ds_read_b64_tr_b16 v[8:9], v18 offset:39680
    buffer_load_dwordx4 v38, s[12:15], s35 offen offset:0 lds
    s_waitcnt lgkmcnt(10)
    v_mfma_f32_32x32x16_bf16 v[96:111], a[176:179], v[26:29], v[96:111]
    ds_read_b64_tr_b16 v[14:15], v18 offset:38976
    ds_read_b64_tr_b16 v[16:17], v18 offset:39744
    s_waitcnt lgkmcnt(9)
    v_mfma_f32_32x32x16_bf16 v[64:79], a[180:183], v[30:33], v[64:79]
    ds_read_b64_tr_b16 v[26:27], v18 offset:39040
    ds_read_b64_tr_b16 v[28:29], v18 offset:39808
    buffer_load_dwordx4 v39, s[12:15], s35 offen offset:1024 lds
    s_waitcnt lgkmcnt(9)
    v_mfma_f32_32x32x16_bf16 v[80:95], a[180:183], v[34:37], v[80:95]
    ds_read_b128 a[188:191], v5 offset:32768
    ds_read_b64_tr_b16 v[30:31], v18 offset:41984
    ds_read_b64_tr_b16 v[32:33], v18 offset:42752
    s_waitcnt lgkmcnt(10)
    v_mfma_f32_32x32x16_bf16 v[96:111], a[180:183], v[52:55], v[96:111]
    ds_read_b64_tr_b16 v[34:35], v18 offset:42048
    ds_read_b64_tr_b16 v[36:37], v18 offset:42816
    buffer_load_dwordx4 v57, s[12:15], s35 offen offset:2048 lds
    s_waitcnt lgkmcnt(9)
    v_mfma_f32_32x32x16_bf16 v[64:79], a[184:187], v[6:9], v[64:79]
    ds_read_b64_tr_b16 v[52:53], v18 offset:42112
    ds_read_b64_tr_b16 v[54:55], v18 offset:42880
    s_waitcnt lgkmcnt(9)
    v_mfma_f32_32x32x16_bf16 v[80:95], a[184:187], v[14:17], v[80:95]
    s_waitcnt vmcnt(14)
    s_barrier
    ds_read_b128 a[192:195], v10
    ds_read_b64_tr_b16 v[6:7], v19 offset:0
    ds_read_b64_tr_b16 v[8:9], v19 offset:768
    s_and_b32 s35, s36, 15
    s_lshr_b64 s[36:37], s[36:37], 4
    s_lshr_b32 s67, s35, 1
    s_lshl_b32 s34, s35, 7
    s_mul_i32 s67, s67, s39
    s_lshl_b32 s35, s35, s38
    s_add_u32 s34, s34, s67
    s_add_u32 m0, s41, 0
    s_nop 0
    buffer_load_dwordx4 v22, s[8:11], s34 offen offset:0 lds
    s_waitcnt lgkmcnt(10)
    v_mfma_f32_32x32x16_bf16 v[96:111], a[184:187], v[26:29], v[96:111]
    ds_read_b64_tr_b16 v[14:15], v19 offset:64
    ds_read_b64_tr_b16 v[16:17], v19 offset:832
    buffer_load_dwordx4 v23, s[8:11], s34 offen offset:1024 lds
    s_waitcnt lgkmcnt(9)
    v_mfma_f32_32x32x16_bf16 v[64:79], a[188:191], v[30:33], v[64:79]
    ds_read_b64_tr_b16 v[26:27], v19 offset:128
    ds_read_b64_tr_b16 v[28:29], v19 offset:896
    s_waitcnt lgkmcnt(9)
    v_mfma_f32_32x32x16_bf16 v[80:95], a[188:191], v[34:37], v[80:95]
    ds_read_b128 a[196:199], v11
    ds_read_b64_tr_b16 v[30:31], v19 offset:3072
    ds_read_b64_tr_b16 v[32:33], v19 offset:3840
    buffer_load_dwordx4 v24, s[8:11], s34 offen offset:2048 lds
    s_waitcnt lgkmcnt(10)
    v_mfma_f32_32x32x16_bf16 v[96:111], a[188:191], v[52:55], v[96:111]
    ds_read_b64_tr_b16 v[34:35], v19 offset:3136
    ds_read_b64_tr_b16 v[36:37], v19 offset:3904
    v_mfma_f32_32x32x16_bf16 v[112:127], v[160:163], v[192:195], v[112:127]
    v_mfma_f32_32x32x16_bf16 v[112:127], v[164:167], v[196:199], v[112:127]
    s_nop 1
    v_mfma_f32_32x32x16_bf16 v[128:143], v[168:171], v[192:195], v[128:143]
    v_cvt_pk_bf16_f32 v160, v64, v65
    v_cvt_pk_bf16_f32 v161, v66, v67
    v_cvt_pk_bf16_f32 v162, v68, v69
    v_cvt_pk_bf16_f32 v163, v70, v71
    v_mfma_f32_32x32x16_bf16 v[128:143], v[172:175], v[196:199], v[128:143]
    v_cvt_pk_bf16_f32 v164, v72, v73
    v_cvt_pk_bf16_f32 v165, v74, v75
    v_cvt_pk_bf16_f32 v166, v76, v77
    v_cvt_pk_bf16_f32 v167, v78, v79
    v_mfma_f32_32x32x16_bf16 v[144:159], v[176:179], v[192:195], v[144:159]
    v_cvt_pk_bf16_f32 v168, v80, v81
    v_cvt_pk_bf16_f32 v169, v82, v83
    v_cvt_pk_bf16_f32 v170, v84, v85
    v_cvt_pk_bf16_f32 v171, v86, v87
    v_mfma_f32_32x32x16_bf16 v[144:159], v[180:183], v[196:199], v[144:159]
    v_cvt_pk_bf16_f32 v172, v88, v89
    v_cvt_pk_bf16_f32 v173, v90, v91
    v_cvt_pk_bf16_f32 v174, v92, v93
    v_cvt_pk_bf16_f32 v175, v94, v95
    s_waitcnt lgkmcnt(9)
    v_mfma_f32_32x32x16_bf16 v[64:79], a[192:195], v[6:9], 0
    ds_read_b64_tr_b16 v[52:53], v19 offset:3200
    ds_read_b64_tr_b16 v[54:55], v19 offset:3968
    buffer_load_dwordx4 v25, s[8:11], s34 offen offset:3072 lds
    s_add_u32 m0, s42, 0
    v_cvt_pk_bf16_f32 v176, v96, v97
    v_cvt_pk_bf16_f32 v177, v98, v99
    v_cvt_pk_bf16_f32 v178, v100, v101
    v_cvt_pk_bf16_f32 v179, v102, v103
    s_waitcnt lgkmcnt(9)
    v_mfma_f32_32x32x16_bf16 v[80:95], a[192:195], v[14:17], 0
    ds_read_b128 a[200:203], v12
    ds_read_b64_tr_b16 v[6:7], v19 offset:6144
    ds_read_b64_tr_b16 v[8:9], v19 offset:6912
    buffer_load_dwordx4 v38, s[12:15], s35 offen offset:0 lds
    v_cvt_pk_bf16_f32 v180, v104, v105
    v_cvt_pk_bf16_f32 v181, v106, v107
    v_cvt_pk_bf16_f32 v182, v108, v109
    v_cvt_pk_bf16_f32 v183, v110, v111
    s_waitcnt lgkmcnt(10)
    v_mfma_f32_32x32x16_bf16 v[96:111], a[192:195], v[26:29], 0
    ds_read_b64_tr_b16 v[14:15], v19 offset:6208
    ds_read_b64_tr_b16 v[16:17], v19 offset:6976
    s_waitcnt lgkmcnt(9)
    v_mfma_f32_32x32x16_bf16 v[64:79], a[196:199], v[30:33], v[64:79]
    ds_read_b64_tr_b16 v[26:27], v19 offset:6272
    ds_read_b64_tr_b16 v[28:29], v19 offset:7040
    buffer_load_dwordx4 v39, s[12:15], s35 offen offset:1024 lds
    s_waitcnt lgkmcnt(9)
    v_mfma_f32_32x32x16_bf16 v[80:95], a[196:199], v[34:37], v[80:95]
    ds_read_b128 a[204:207], v13
    ds_read_b64_tr_b16 v[30:31], v19 offset:9216
    ds_read_b64_tr_b16 v[32:33], v19 offset:9984
    s_waitcnt lgkmcnt(10)
    v_mfma_f32_32x32x16_bf16 v[96:111], a[196:199], v[52:55], v[96:111]
    ds_read_b64_tr_b16 v[34:35], v19 offset:9280
    ds_read_b64_tr_b16 v[36:37], v19 offset:10048
    buffer_load_dwordx4 v57, s[12:15], s35 offen offset:2048 lds
    s_waitcnt lgkmcnt(9)
    v_mfma_f32_32x32x16_bf16 v[64:79], a[200:203], v[6:9], v[64:79]
    ds_read_b64_tr_b16 v[52:53], v19 offset:9344
    ds_read_b64_tr_b16 v[54:55], v19 offset:10112
    s_waitcnt lgkmcnt(9)
    v_mfma_f32_32x32x16_bf16 v[80:95], a[200:203], v[14:17], v[80:95]
    s_waitcnt vmcnt(14)
    s_barrier
    ds_read_b128 a[208:211], v10 offset:32768
    ds_read_b64_tr_b16 v[6:7], v19 offset:32768
    ds_read_b64_tr_b16 v[8:9], v19 offset:33536
    v_and_b32 v51, 3, v1
    v_lshlrev_b32 v51, 4, v51
    v_lshrrev_b32 v50, 2, v1
    v_lshl_add_u32 v50, v50, 11, v51
    s_lshl_b32 s65, s29, 6
    s_add_u32 s65, s65, s46
    v_add_u32 v22, s65, v50
    v_add_u32 v23, 31744, v22
    v_add_u32 v24, 63488, v22
    v_add_u32 v25, 95232, v22
    v_bfe_u32 v50, v1, 4, 1
    v_lshlrev_b32 v50, 5, v50
    v_and_b32 v51, 1, v1
    v_lshl_add_u32 v50, v51, 4, v50
    v_bfe_u32 v51, v1, 1, 1
    v_lshl_add_u32 v50, v51, 3, v50
    v_bfe_u32 v51, v1, 2, 2
    v_lshl_add_u32 v50, v51, 6, v50
    v_lshrrev_b32 v51, 5, v1
    v_lshl_add_u32 v38, v51, 9, v50
    v_add_u32 v39, 0x10000, v38
    s_lshl_b32 s65, s32, 3
    s_add_u32 s65, s65, 262144
    s_bfe_u32 s67, s4, s65
    s_lshl_b32 s67, s67, 17
    s_lshl_b32 s65, s32, 13
    s_add_u32 m0, s65, 32768
    s_waitcnt lgkmcnt(10)
    v_mfma_f32_32x32x16_bf16 v[96:111], a[200:203], v[26:29], v[96:111]
    ds_read_b64_tr_b16 v[14:15], v19 offset:32832
    ds_read_b64_tr_b16 v[16:17], v19 offset:33600
    buffer_load_dwordx4 v22, s[12:15], s67 offen offset:0 lds
    s_waitcnt lgkmcnt(9)
    v_mfma_f32_32x32x16_bf16 v[64:79], a[204:207], v[30:33], v[64:79]
    ds_read_b64_tr_b16 v[26:27], v19 offset:32896
    ds_read_b64_tr_b16 v[28:29], v19 offset:33664
    s_waitcnt lgkmcnt(9)
    v_mfma_f32_32x32x16_bf16 v[80:95], a[204:207], v[34:37], v[80:95]
    ds_read_b128 a[212:215], v11 offset:32768
    ds_read_b64_tr_b16 v[30:31], v19 offset:35840
    ds_read_b64_tr_b16 v[32:33], v19 offset:36608
    s_waitcnt lgkmcnt(10)
    v_mfma_f32_32x32x16_bf16 v[96:111], a[204:207], v[52:55], v[96:111]
    ds_read_b64_tr_b16 v[34:35], v19 offset:35904
    ds_read_b64_tr_b16 v[36:37], v19 offset:36672
    buffer_load_dwordx4 v23, s[12:15], s67 offen offset:1024 lds
    s_waitcnt lgkmcnt(9)
    v_mfma_f32_32x32x16_bf16 v[64:79], a[208:211], v[6:9], v[64:79]
    ds_read_b64_tr_b16 v[52:53], v19 offset:35968
    ds_read_b64_tr_b16 v[54:55], v19 offset:36736
    s_waitcnt lgkmcnt(9)
    v_mfma_f32_32x32x16_bf16 v[80:95], a[208:211], v[14:17], v[80:95]
    ds_read_b128 a[216:219], v12 offset:32768
    ds_read_b64_tr_b16 v[6:7], v19 offset:38912
    ds_read_b64_tr_b16 v[8:9], v19 offset:39680
    s_waitcnt lgkmcnt(10)
    v_mfma_f32_32x32x16_bf16 v[96:111], a[208:211], v[26:29], v[96:111]
    ds_read_b64_tr_b16 v[14:15], v19 offset:38976
    ds_read_b64_tr_b16 v[16:17], v19 offset:39744
    buffer_load_dwordx4 v24, s[12:15], s67 offen offset:2048 lds
    s_waitcnt lgkmcnt(9)
    v_mfma_f32_32x32x16_bf16 v[64:79], a[212:215], v[30:33], v[64:79]
    ds_read_b64_tr_b16 v[26:27], v19 offset:39040
    ds_read_b64_tr_b16 v[28:29], v19 offset:39808
    s_waitcnt lgkmcnt(9)
    v_mfma_f32_32x32x16_bf16 v[80:95], a[212:215], v[34:37], v[80:95]
    ds_read_b128 a[220:223], v13 offset:32768
    ds_read_b64_tr_b16 v[30:31], v19 offset:41984
    ds_read_b64_tr_b16 v[32:33], v19 offset:42752
    s_waitcnt lgkmcnt(10)
    v_mfma_f32_32x32x16_bf16 v[96:111], a[212:215], v[52:55], v[96:111]
    ds_read_b64_tr_b16 v[34:35], v19 offset:42048
    ds_read_b64_tr_b16 v[36:37], v19 offset:42816
    buffer_load_dwordx4 v25, s[12:15], s67 offen offset:3072 lds
    s_waitcnt lgkmcnt(9)
    v_mfma_f32_32x32x16_bf16 v[64:79], a[216:219], v[6:9], v[64:79]
    ds_read_b64_tr_b16 v[52:53], v19 offset:42112
    ds_read_b64_tr_b16 v[54:55], v19 offset:42880
    s_waitcnt lgkmcnt(9)
    v_mfma_f32_32x32x16_bf16 v[80:95], a[216:219], v[14:17], v[80:95]
    s_waitcnt vmcnt(11)
    s_barrier
    ds_read_b128 a[224:227], v40
    ds_read_b64_tr_b16 v[6:7], v20 offset:0
    ds_read_b64_tr_b16 v[8:9], v20 offset:768
    s_lshl_b32 s65, s32, 3
    s_add_u32 s65, s65, 262148
    s_bfe_u32 s67, s4, s65
    s_lshl_b32 s67, s67, 17
    s_lshl_b32 s65, s32, 13
    s_add_u32 m0, s65, 36864
    s_waitcnt lgkmcnt(10)
    v_mfma_f32_32x32x16_bf16 v[96:111], a[216:219], v[26:29], v[96:111]
    ds_read_b64_tr_b16 v[14:15], v20 offset:64
    ds_read_b64_tr_b16 v[16:17], v20 offset:832
    buffer_load_dwordx4 v22, s[12:15], s67 offen offset:0 lds
    s_waitcnt lgkmcnt(9)
    v_mfma_f32_32x32x16_bf16 v[64:79], a[220:223], v[30:33], v[64:79]
    ds_read_b64_tr_b16 v[26:27], v20 offset:128
    ds_read_b64_tr_b16 v[28:29], v20 offset:896
    s_waitcnt lgkmcnt(9)
    v_mfma_f32_32x32x16_bf16 v[80:95], a[220:223], v[34:37], v[80:95]
    ds_read_b128 a[228:231], v41
    ds_read_b64_tr_b16 v[30:31], v20 offset:3072
    ds_read_b64_tr_b16 v[32:33], v20 offset:3840
    s_waitcnt lgkmcnt(10)
    v_mfma_f32_32x32x16_bf16 v[96:111], a[220:223], v[52:55], v[96:111]
    ds_read_b64_tr_b16 v[34:35], v20 offset:3136
    ds_read_b64_tr_b16 v[36:37], v20 offset:3904
    buffer_load_dwordx4 v23, s[12:15], s67 offen offset:1024 lds
    v_mfma_f32_32x32x16_bf16 v[112:127], v[160:163], v[200:203], v[112:127]
    v_mfma_f32_32x32x16_bf16 v[112:127], v[164:167], v[204:207], v[112:127]
    s_nop 1
    v_mfma_f32_32x32x16_bf16 v[128:143], v[168:171], v[200:203], v[128:143]
    v_cvt_pk_bf16_f32 v160, v64, v65
    v_cvt_pk_bf16_f32 v161, v66, v67
    v_cvt_pk_bf16_f32 v162, v68, v69
    v_cvt_pk_bf16_f32 v163, v70, v71
    v_mfma_f32_32x32x16_bf16 v[128:143], v[172:175], v[204:207], v[128:143]
    v_cvt_pk_bf16_f32 v164, v72, v73
    v_cvt_pk_bf16_f32 v165, v74, v75
    v_cvt_pk_bf16_f32 v166, v76, v77
    v_cvt_pk_bf16_f32 v167, v78, v79
    v_mfma_f32_32x32x16_bf16 v[144:159], v[176:179], v[200:203], v[144:159]
    v_cvt_pk_bf16_f32 v168, v80, v81
    v_cvt_pk_bf16_f32 v169, v82, v83
    v_cvt_pk_bf16_f32 v170, v84, v85
    v_cvt_pk_bf16_f32 v171, v86, v87
    v_mfma_f32_32x32x16_bf16 v[144:159], v[180:183], v[204:207], v[144:159]
    v_cvt_pk_bf16_f32 v172, v88, v89
    v_cvt_pk_bf16_f32 v173, v90, v91
    v_cvt_pk_bf16_f32 v174, v92, v93
    v_cvt_pk_bf16_f32 v175, v94, v95
    s_waitcnt lgkmcnt(9)
    v_mfma_f32_32x32x16_bf16 v[64:79], a[224:227], v[6:9], 0
    ds_read_b64_tr_b16 v[52:53], v20 offset:3200
    ds_read_b64_tr_b16 v[54:55], v20 offset:3968
    v_cvt_pk_bf16_f32 v176, v96, v97
    v_cvt_pk_bf16_f32 v177, v98, v99
    v_cvt_pk_bf16_f32 v178, v100, v101
    v_cvt_pk_bf16_f32 v179, v102, v103
    s_waitcnt lgkmcnt(9)
    v_mfma_f32_32x32x16_bf16 v[80:95], a[224:227], v[14:17], 0
    ds_read_b128 a[232:235], v42
    ds_read_b64_tr_b16 v[6:7], v20 offset:6144
    ds_read_b64_tr_b16 v[8:9], v20 offset:6912
    v_cvt_pk_bf16_f32 v180, v104, v105
    v_cvt_pk_bf16_f32 v181, v106, v107
    v_cvt_pk_bf16_f32 v182, v108, v109
    v_cvt_pk_bf16_f32 v183, v110, v111
    s_waitcnt lgkmcnt(10)
    v_mfma_f32_32x32x16_bf16 v[96:111], a[224:227], v[26:29], 0
    ds_read_b64_tr_b16 v[14:15], v20 offset:6208
    ds_read_b64_tr_b16 v[16:17], v20 offset:6976
    buffer_load_dwordx4 v24, s[12:15], s67 offen offset:2048 lds
    s_waitcnt lgkmcnt(9)
    v_mfma_f32_32x32x16_bf16 v[64:79], a[228:231], v[30:33], v[64:79]
    ds_read_b64_tr_b16 v[26:27], v20 offset:6272
    ds_read_b64_tr_b16 v[28:29], v20 offset:7040
    s_waitcnt lgkmcnt(9)
    v_mfma_f32_32x32x16_bf16 v[80:95], a[228:231], v[34:37], v[80:95]
    ds_read_b128 a[236:239], v43
    ds_read_b64_tr_b16 v[30:31], v20 offset:9216
    ds_read_b64_tr_b16 v[32:33], v20 offset:9984
    s_waitcnt lgkmcnt(10)
    v_mfma_f32_32x32x16_bf16 v[96:111], a[228:231], v[52:55], v[96:111]
    ds_read_b64_tr_b16 v[34:35], v20 offset:9280
    ds_read_b64_tr_b16 v[36:37], v20 offset:10048
    buffer_load_dwordx4 v25, s[12:15], s67 offen offset:3072 lds
    s_waitcnt lgkmcnt(9)
    v_mfma_f32_32x32x16_bf16 v[64:79], a[232:235], v[6:9], v[64:79]
    ds_read_b64_tr_b16 v[52:53], v20 offset:9344
    ds_read_b64_tr_b16 v[54:55], v20 offset:10112
    s_waitcnt lgkmcnt(9)
    v_mfma_f32_32x32x16_bf16 v[80:95], a[232:235], v[14:17], v[80:95]
    s_waitcnt vmcnt(8)
    s_barrier
    ds_read_b128 a[240:243], v2
    ds_read_b64_tr_b16 v[6:7], v18 offset:0
    ds_read_b64_tr_b16 v[8:9], v18 offset:768
    s_lshl_b32 s65, s32, 3
    s_add_u32 s65, s65, 262144
    s_bfe_u32 s67, s5, s65
    s_lshl_b32 s67, s67, 17
    s_lshl_b32 s65, s32, 13
    s_add_u32 m0, s65, 65536
    s_waitcnt lgkmcnt(10)
    v_mfma_f32_32x32x16_bf16 v[96:111], a[232:235], v[26:29], v[96:111]
    ds_read_b64_tr_b16 v[14:15], v18 offset:64
    ds_read_b64_tr_b16 v[16:17], v18 offset:832
    buffer_load_dwordx4 v22, s[12:15], s67 offen offset:0 lds
    s_waitcnt lgkmcnt(9)
    v_mfma_f32_32x32x16_bf16 v[64:79], a[236:239], v[30:33], v[64:79]
    ds_read_b64_tr_b16 v[26:27], v18 offset:128
    ds_read_b64_tr_b16 v[28:29], v18 offset:896
    s_waitcnt lgkmcnt(9)
    v_mfma_f32_32x32x16_bf16 v[80:95], a[236:239], v[34:37], v[80:95]
    ds_read_b128 a[244:247], v3
    ds_read_b64_tr_b16 v[30:31], v18 offset:3072
    ds_read_b64_tr_b16 v[32:33], v18 offset:3840
    s_waitcnt lgkmcnt(10)
    v_mfma_f32_32x32x16_bf16 v[96:111], a[236:239], v[52:55], v[96:111]
    ds_read_b64_tr_b16 v[34:35], v18 offset:3136
    ds_read_b64_tr_b16 v[36:37], v18 offset:3904
    buffer_load_dwordx4 v23, s[12:15], s67 offen offset:1024 lds
    s_waitcnt lgkmcnt(9)
    v_mfma_f32_32x32x16_bf16 v[64:79], a[240:243], v[6:9], v[64:79]
    ds_read_b64_tr_b16 v[52:53], v18 offset:3200
    ds_read_b64_tr_b16 v[54:55], v18 offset:3968
    s_waitcnt lgkmcnt(9)
    v_mfma_f32_32x32x16_bf16 v[80:95], a[240:243], v[14:17], v[80:95]
    ds_read_b128 a[248:251], v4
    ds_read_b64_tr_b16 v[6:7], v18 offset:6144
    ds_read_b64_tr_b16 v[8:9], v18 offset:6912
    s_waitcnt lgkmcnt(10)
    v_mfma_f32_32x32x16_bf16 v[96:111], a[240:243], v[26:29], v[96:111]
    ds_read_b64_tr_b16 v[14:15], v18 offset:6208
    ds_read_b64_tr_b16 v[16:17], v18 offset:6976
    buffer_load_dwordx4 v24, s[12:15], s67 offen offset:2048 lds
    s_waitcnt lgkmcnt(9)
    v_mfma_f32_32x32x16_bf16 v[64:79], a[244:247], v[30:33], v[64:79]
    ds_read_b64_tr_b16 v[26:27], v18 offset:6272
    ds_read_b64_tr_b16 v[28:29], v18 offset:7040
    s_waitcnt lgkmcnt(9)
    v_mfma_f32_32x32x16_bf16 v[80:95], a[244:247], v[34:37], v[80:95]
    ds_read_b128 a[252:255], v5
    ds_read_b64_tr_b16 v[30:31], v18 offset:9216
    ds_read_b64_tr_b16 v[32:33], v18 offset:9984
    s_waitcnt lgkmcnt(10)
    v_mfma_f32_32x32x16_bf16 v[96:111], a[244:247], v[52:55], v[96:111]
    ds_read_b64_tr_b16 v[34:35], v18 offset:9280
    ds_read_b64_tr_b16 v[36:37], v18 offset:10048
    buffer_load_dwordx4 v25, s[12:15], s67 offen offset:3072 lds
    s_waitcnt lgkmcnt(9)
    v_mfma_f32_32x32x16_bf16 v[64:79], a[248:251], v[6:9], v[64:79]
    ds_read_b64_tr_b16 v[52:53], v18 offset:9344
    ds_read_b64_tr_b16 v[54:55], v18 offset:10112
    s_waitcnt lgkmcnt(9)
    v_mfma_f32_32x32x16_bf16 v[80:95], a[248:251], v[14:17], v[80:95]
    s_waitcnt vmcnt(4)
    s_barrier
    s_lshl_b32 s65, s32, 3
    s_add_u32 s65, s65, 262148
    s_bfe_u32 s67, s5, s65
    s_lshl_b32 s67, s67, 17
    s_lshl_b32 s65, s32, 13
    s_add_u32 m0, s65, 69632
    s_waitcnt lgkmcnt(7)
    v_mfma_f32_32x32x16_bf16 v[96:111], a[248:251], v[26:29], v[96:111]
    buffer_load_dwordx4 v22, s[12:15], s67 offen offset:0 lds
    s_waitcnt lgkmcnt(4)
    v_mfma_f32_32x32x16_bf16 v[64:79], a[252:255], v[30:33], v[64:79]
    s_waitcnt lgkmcnt(2)
    v_mfma_f32_32x32x16_bf16 v[80:95], a[252:255], v[34:37], v[80:95]
    s_waitcnt lgkmcnt(0)
    v_mfma_f32_32x32x16_bf16 v[96:111], a[252:255], v[52:55], v[96:111]
    buffer_load_dwordx4 v23, s[12:15], s67 offen offset:1024 lds
    v_mfma_f32_32x32x16_bf16 v[112:127], v[160:163], v[208:211], v[112:127]
    v_mfma_f32_32x32x16_bf16 v[112:127], v[164:167], v[212:215], v[112:127]
    s_nop 6
    v_mfma_f32_32x32x16_bf16 v[128:143], v[168:171], v[208:211], v[128:143]
    v_cvt_pk_bf16_f32 v160, v64, v65
    v_cvt_pk_bf16_f32 v161, v66, v67
    v_cvt_pk_bf16_f32 v162, v68, v69
    v_cvt_pk_bf16_f32 v163, v70, v71
    v_mfma_f32_32x32x16_bf16 v[128:143], v[172:175], v[212:215], v[128:143]
    v_cvt_pk_bf16_f32 v164, v72, v73
    v_cvt_pk_bf16_f32 v165, v74, v75
    v_cvt_pk_bf16_f32 v166, v76, v77
    v_cvt_pk_bf16_f32 v167, v78, v79
    v_mfma_f32_32x32x16_bf16 v[144:159], v[176:179], v[208:211], v[144:159]
    v_cvt_pk_bf16_f32 v168, v80, v81
    v_cvt_pk_bf16_f32 v169, v82, v83
    v_cvt_pk_bf16_f32 v170, v84, v85
    v_cvt_pk_bf16_f32 v171, v86, v87
    v_mfma_f32_32x32x16_bf16 v[144:159], v[180:183], v[212:215], v[144:159]
    v_cvt_pk_bf16_f32 v172, v88, v89
    v_cvt_pk_bf16_f32 v173, v90, v91
    v_cvt_pk_bf16_f32 v174, v92, v93
    v_cvt_pk_bf16_f32 v175, v94, v95
    v_cvt_pk_bf16_f32 v176, v96, v97
    v_cvt_pk_bf16_f32 v177, v98, v99
    v_cvt_pk_bf16_f32 v178, v100, v101
    v_cvt_pk_bf16_f32 v179, v102, v103
    v_cvt_pk_bf16_f32 v180, v104, v105
    v_cvt_pk_bf16_f32 v181, v106, v107
    v_cvt_pk_bf16_f32 v182, v108, v109
    v_cvt_pk_bf16_f32 v183, v110, v111
    s_lshl_b32 s60, s28, 2
    s_add_u32 s60, s60, s30
    s_lshl_b32 s60, s60, 3
    s_add_u32 s60, s60, s33
    v_mfma_f32_32x32x16_bf16 v[112:127], v[160:163], v[216:219], v[112:127]
    v_mfma_f32_32x32x16_bf16 v[112:127], v[164:167], v[220:223], v[112:127]
    v_mfma_f32_32x32x16_bf16 v[128:143], v[168:171], v[216:219], v[128:143]
    v_mfma_f32_32x32x16_bf16 v[128:143], v[172:175], v[220:223], v[128:143]
    v_mfma_f32_32x32x16_bf16 v[144:159], v[176:179], v[216:219], v[144:159]
    v_mfma_f32_32x32x16_bf16 v[144:159], v[180:183], v[220:223], v[144:159]
    ds_read_b64_tr_b16 v[6:7], v38 offset:32768
    ds_read_b64_tr_b16 v[8:9], v38 offset:33024
    ds_read_b64_tr_b16 v[14:15], v38 offset:33792
    ds_read_b64_tr_b16 v[16:17], v38 offset:34048
    ds_read_b64_tr_b16 v[26:27], v38 offset:34816
    ds_read_b64_tr_b16 v[28:29], v38 offset:35072
    ds_read_b64_tr_b16 v[30:31], v38 offset:35840
    ds_read_b64_tr_b16 v[32:33], v38 offset:36096
    ds_read_b64_tr_b16 v[34:35], v38 offset:36864
    ds_read_b64_tr_b16 v[36:37], v38 offset:37120
    ds_read_b64_tr_b16 v[52:53], v38 offset:37888
    ds_read_b64_tr_b16 v[54:55], v38 offset:38144
    ds_read_b64_tr_b16 v[2:3], v38 offset:38912
    ds_read_b64_tr_b16 v[4:5], v38 offset:39168
    s_waitcnt lgkmcnt(12)
    v_mfma_f32_32x32x16_bf16 v[64:79], a[0:3], v[6:9], 0
    ds_read_b64_tr_b16 v[10:11], v38 offset:39936
    ds_read_b64_tr_b16 v[12:13], v38 offset:40192
    buffer_load_dwordx4 v24, s[12:15], s67 offen offset:2048 lds
    buffer_load_dwordx4 v25, s[12:15], s67 offen offset:3072 lds
    s_lshl_b32 s61, s60, 17
    s_lshl_b32 s62, s32, 11
    s_waitcnt lgkmcnt(12)
    v_mfma_f32_32x32x16_bf16 v[64:79], a[4:7], v[14:17], v[64:79]
    ds_read_b64_tr_b16 v[6:7], v38 offset:40960
    ds_read_b64_tr_b16 v[8:9], v38 offset:41216
    s_add_u32 s61, s61, s62
    s_add_u32 s61, s61, 4194304
    s_lshl_b32 s62, s29, 13
    s_add_u32 s62, s62, s61
    s_waitcnt lgkmcnt(12)
    v_mfma_f32_32x32x16_bf16 v[64:79], a[8:11], v[26:29], v[64:79]
    ds_read_b64_tr_b16 v[14:15], v38 offset:41984
    ds_read_b64_tr_b16 v[16:17], v38 offset:42240
    v_cvt_pk_bf16_f32 v224, v112, v113
    v_cvt_pk_bf16_f32 v225, v114, v115
    v_cvt_pk_bf16_f32 v226, v116, v117
    v_cvt_pk_bf16_f32 v227, v118, v119
    s_waitcnt lgkmcnt(12)
    v_mfma_f32_32x32x16_bf16 v[64:79], a[12:15], v[30:33], v[64:79]
    ds_read_b64_tr_b16 v[26:27], v38 offset:43008
    ds_read_b64_tr_b16 v[28:29], v38 offset:43264
    v_cvt_pk_bf16_f32 v228, v120, v121
    v_cvt_pk_bf16_f32 v229, v122, v123
    v_cvt_pk_bf16_f32 v230, v124, v125
    v_cvt_pk_bf16_f32 v231, v126, v127
    s_waitcnt lgkmcnt(12)
    v_mfma_f32_32x32x16_bf16 v[64:79], a[16:19], v[34:37], v[64:79]
    ds_read_b64_tr_b16 v[30:31], v38 offset:44032
    ds_read_b64_tr_b16 v[32:33], v38 offset:44288
    s_xor_b32 s43, s29, 1
    s_lshl_b32 s43, s43, 15
    s_add_u32 s43, s43, s62
    buffer_store_dwordx4 v[224:227], v44, s[16:19], s43 offen sc1
    buffer_store_dwordx4 v[228:231], v44, s[16:19], s43 offen offset:1024 sc1
    v_cvt_pk_bf16_f32 v176, v128, v129
    s_waitcnt lgkmcnt(12)
    v_mfma_f32_32x32x16_bf16 v[64:79], a[20:23], v[52:55], v[64:79]
    ds_read_b64_tr_b16 v[34:35], v38 offset:45056
    ds_read_b64_tr_b16 v[36:37], v38 offset:45312
    v_cvt_pk_bf16_f32 v177, v130, v131
    v_cvt_pk_bf16_f32 v178, v132, v133
    v_cvt_pk_bf16_f32 v179, v134, v135
    v_cvt_pk_bf16_f32 v180, v136, v137
    s_waitcnt lgkmcnt(12)
    v_mfma_f32_32x32x16_bf16 v[64:79], a[24:27], v[2:5], v[64:79]
    ds_read_b64_tr_b16 v[52:53], v38 offset:46080
    ds_read_b64_tr_b16 v[54:55], v38 offset:46336
    v_cvt_pk_bf16_f32 v181, v138, v139
    v_cvt_pk_bf16_f32 v182, v140, v141
    v_cvt_pk_bf16_f32 v183, v142, v143
    s_xor_b32 s43, s29, 2
    s_lshl_b32 s43, s43, 15
    s_add_u32 s43, s43, s62
    s_waitcnt lgkmcnt(12)
    v_mfma_f32_32x32x16_bf16 v[64:79], a[28:31], v[10:13], v[64:79]
    ds_read_b64_tr_b16 v[2:3], v38 offset:47104
    ds_read_b64_tr_b16 v[4:5], v38 offset:47360
    buffer_store_dwordx4 v[176:179], v44, s[16:19], s43 offen sc1
    buffer_store_dwordx4 v[180:183], v44, s[16:19], s43 offen offset:1024 sc1
    v_cvt_pk_bf16_f32 v224, v144, v145
    v_cvt_pk_bf16_f32 v225, v146, v147
    s_waitcnt lgkmcnt(12)
    v_mfma_f32_32x32x16_bf16 v[80:95], a[32:35], v[6:9], 0
    ds_read_b64_tr_b16 v[10:11], v38 offset:48128
    ds_read_b64_tr_b16 v[12:13], v38 offset:48384
    v_cvt_pk_bf16_f32 v226, v148, v149
    v_cvt_pk_bf16_f32 v227, v150, v151
    v_cvt_pk_bf16_f32 v228, v152, v153
    v_cvt_pk_bf16_f32 v229, v154, v155
    s_waitcnt lgkmcnt(12)
    v_mfma_f32_32x32x16_bf16 v[80:95], a[36:39], v[14:17], v[80:95]
    ds_read_b64_tr_b16 v[6:7], v38 offset:49152
    ds_read_b64_tr_b16 v[8:9], v38 offset:49408
    v_cvt_pk_bf16_f32 v230, v156, v157
    v_cvt_pk_bf16_f32 v231, v158, v159
    s_xor_b32 s43, s29, 3
    s_lshl_b32 s43, s43, 15
    s_add_u32 s43, s43, s62
    buffer_store_dwordx4 v[224:227], v44, s[16:19], s43 offen sc1
    s_waitcnt lgkmcnt(12)
    v_mfma_f32_32x32x16_bf16 v[80:95], a[40:43], v[26:29], v[80:95]
    ds_read_b64_tr_b16 v[14:15], v38 offset:50176
    ds_read_b64_tr_b16 v[16:17], v38 offset:50432
    buffer_store_dwordx4 v[228:231], v44, s[16:19], s43 offen offset:1024 sc1
    s_lshl_b32 s64, s60, 11
    s_lshl_b32 s63, s32, 7
    s_add_u32 s64, s64, s63
    s_waitcnt lgkmcnt(12)
    v_mfma_f32_32x32x16_bf16 v[80:95], a[44:47], v[30:33], v[80:95]
    ds_read_b64_tr_b16 v[26:27], v38 offset:51200
    ds_read_b64_tr_b16 v[28:29], v38 offset:51456
    v_cvt_pk_bf16_f32 v160, v64, v65
    v_cvt_pk_bf16_f32 v161, v66, v67
    v_cvt_pk_bf16_f32 v162, v68, v69
    v_cvt_pk_bf16_f32 v163, v70, v71
    s_waitcnt lgkmcnt(12)
    v_mfma_f32_32x32x16_bf16 v[80:95], a[48:51], v[34:37], v[80:95]
    ds_read_b64_tr_b16 v[30:31], v38 offset:52224
    ds_read_b64_tr_b16 v[32:33], v38 offset:52480
    v_cvt_pk_bf16_f32 v164, v72, v73
    v_cvt_pk_bf16_f32 v165, v74, v75
    v_cvt_pk_bf16_f32 v166, v76, v77
    v_cvt_pk_bf16_f32 v167, v78, v79
    s_waitcnt lgkmcnt(12)
    v_mfma_f32_32x32x16_bf16 v[80:95], a[52:55], v[52:55], v[80:95]
    ds_read_b64_tr_b16 v[34:35], v38 offset:53248
    ds_read_b64_tr_b16 v[36:37], v38 offset:53504
    s_add_u32 s64, s64, 65536
    v_xor_b32 v46, s29, v1
    v_lshlrev_b32 v46, 9, v46
    s_lshl_b32 s63, s29, 2
    v_mfma_f32_32x32x16_bf16 v[96:111], v[160:163], v[232:235], 0
    v_add_u32 v46, s63, v46
    v_mov_b32 v47, s44
    s_lshl_b32 s63, s29, 9
    s_add_u32 s63, s63, s64
    v_mfma_f32_32x32x16_bf16 v[96:111], v[164:167], v[236:239], v[96:111]
    s_add_u32 s50, s16, s63
    s_addc_u32 s51, s17, 0
    s_lshl_b32 s63, s29, 15
    s_add_u32 s61, s61, s63
    v_and_b32 v48, 31, v1
    s_waitcnt lgkmcnt(12)
    v_mfma_f32_32x32x16_bf16 v[80:95], a[56:59], v[2:5], v[80:95]
    ds_read_b64_tr_b16 v[52:53], v38 offset:54272
    ds_read_b64_tr_b16 v[54:55], v38 offset:54528
    v_lshlrev_b32 v48, 12, v48
    v_lshrrev_b32 v49, 5, v1
    v_lshl_add_u32 v48, v49, 4, v48
    s_lshr_b32 s34, s47, 5
    s_waitcnt lgkmcnt(12)
    v_mfma_f32_32x32x16_bf16 v[80:95], a[60:63], v[10:13], v[80:95]
    ds_read_b64_tr_b16 v[2:3], v38 offset:55296
    ds_read_b64_tr_b16 v[4:5], v38 offset:55552
    s_lshl_b32 s34, s34, 17
    s_lshl_b32 s63, s28, 11
    s_add_u32 s34, s34, s63
    s_lshl_b32 s63, s33, 8
    s_waitcnt lgkmcnt(12)
    v_mfma_f32_32x32x16_bf16 v[64:79], a[64:67], v[6:9], 0
    ds_read_b64_tr_b16 v[10:11], v38 offset:56320
    ds_read_b64_tr_b16 v[12:13], v38 offset:56576
    s_add_u32 s34, s34, s63
    s_lshl_b32 s63, s29, 6
    s_add_u32 s34, s34, s63
    s_waitcnt lgkmcnt(12)
    v_mfma_f32_32x32x16_bf16 v[64:79], a[68:71], v[14:17], v[64:79]
    ds_read_b64_tr_b16 v[6:7], v38 offset:57344
    ds_read_b64_tr_b16 v[8:9], v38 offset:57600
    s_waitcnt lgkmcnt(12)
    v_mfma_f32_32x32x16_bf16 v[64:79], a[72:75], v[26:29], v[64:79]
    ds_read_b64_tr_b16 v[14:15], v38 offset:58368
    ds_read_b64_tr_b16 v[16:17], v38 offset:58624
    s_waitcnt lgkmcnt(12)
    v_mfma_f32_32x32x16_bf16 v[64:79], a[76:79], v[30:33], v[64:79]
    ds_read_b64_tr_b16 v[26:27], v38 offset:59392
    ds_read_b64_tr_b16 v[28:29], v38 offset:59648
    v_cvt_pk_bf16_f32 v168, v80, v81
    v_cvt_pk_bf16_f32 v169, v82, v83
    v_cvt_pk_bf16_f32 v170, v84, v85
    v_cvt_pk_bf16_f32 v171, v86, v87
    s_waitcnt lgkmcnt(12)
    v_mfma_f32_32x32x16_bf16 v[64:79], a[80:83], v[34:37], v[64:79]
    ds_read_b64_tr_b16 v[30:31], v38 offset:60416
    ds_read_b64_tr_b16 v[32:33], v38 offset:60672
    v_cvt_pk_bf16_f32 v172, v88, v89
    v_cvt_pk_bf16_f32 v173, v90, v91
    v_cvt_pk_bf16_f32 v174, v92, v93
    v_cvt_pk_bf16_f32 v175, v94, v95
    s_waitcnt lgkmcnt(12)
    v_mfma_f32_32x32x16_bf16 v[64:79], a[84:87], v[52:55], v[64:79]
    ds_read_b64_tr_b16 v[34:35], v38 offset:61440
    ds_read_b64_tr_b16 v[36:37], v38 offset:61696
    v_mfma_f32_32x32x16_bf16 v[96:111], v[168:171], v[240:243], v[96:111]
    v_mfma_f32_32x32x16_bf16 v[96:111], v[172:175], v[244:247], v[96:111]
    s_waitcnt lgkmcnt(12)
    v_mfma_f32_32x32x16_bf16 v[64:79], a[88:91], v[2:5], v[64:79]
    ds_read_b64_tr_b16 v[52:53], v38 offset:62464
    ds_read_b64_tr_b16 v[54:55], v38 offset:62720
    s_waitcnt lgkmcnt(12)
    v_mfma_f32_32x32x16_bf16 v[64:79], a[92:95], v[10:13], v[64:79]
    ds_read_b64_tr_b16 v[2:3], v38 offset:63488
    ds_read_b64_tr_b16 v[4:5], v38 offset:63744
    s_waitcnt lgkmcnt(12)
    v_mfma_f32_32x32x16_bf16 v[80:95], a[96:99], v[6:9], 0
    ds_read_b64_tr_b16 v[10:11], v38 offset:64512
    ds_read_b64_tr_b16 v[12:13], v38 offset:64768
    s_waitcnt lgkmcnt(12)
    v_mfma_f32_32x32x16_bf16 v[80:95], a[100:103], v[14:17], v[80:95]
    s_waitcnt vmcnt(6)
    s_barrier
    ds_read_b64_tr_b16 v[6:7], v39 offset:0
    ds_read_b64_tr_b16 v[8:9], v39 offset:256
    s_waitcnt lgkmcnt(12)
    v_mfma_f32_32x32x16_bf16 v[80:95], a[104:107], v[26:29], v[80:95]
    ds_read_b64_tr_b16 v[14:15], v39 offset:1024
    ds_read_b64_tr_b16 v[16:17], v39 offset:1280
    s_waitcnt vmcnt(0)
    s_mov_b64 exec, 14
    buffer_store_dword v47, v46, s[16:19], s64 offen sc1
    s_mov_b64 exec, -1
    s_waitcnt lgkmcnt(12)
    v_mfma_f32_32x32x16_bf16 v[80:95], a[108:111], v[30:33], v[80:95]
    ds_read_b64_tr_b16 v[26:27], v39 offset:2048
    ds_read_b64_tr_b16 v[28:29], v39 offset:2304
    v_cvt_pk_bf16_f32 v160, v64, v65
    v_cvt_pk_bf16_f32 v161, v66, v67
    v_cvt_pk_bf16_f32 v162, v68, v69
    v_cvt_pk_bf16_f32 v163, v70, v71
    s_waitcnt lgkmcnt(12)
    v_mfma_f32_32x32x16_bf16 v[80:95], a[112:115], v[34:37], v[80:95]
    ds_read_b64_tr_b16 v[30:31], v39 offset:3072
    ds_read_b64_tr_b16 v[32:33], v39 offset:3328
    v_cvt_pk_bf16_f32 v164, v72, v73
    v_cvt_pk_bf16_f32 v165, v74, v75
    v_cvt_pk_bf16_f32 v166, v76, v77
    v_cvt_pk_bf16_f32 v167, v78, v79
    s_waitcnt lgkmcnt(12)
    v_mfma_f32_32x32x16_bf16 v[80:95], a[116:119], v[52:55], v[80:95]
    ds_read_b64_tr_b16 v[34:35], v39 offset:4096
    ds_read_b64_tr_b16 v[36:37], v39 offset:4352
    v_mfma_f32_32x32x16_bf16 v[96:111], v[160:163], v[248:251], v[96:111]
    v_mfma_f32_32x32x16_bf16 v[96:111], v[164:167], v[252:255], v[96:111]
    s_waitcnt lgkmcnt(12)
    v_mfma_f32_32x32x16_bf16 v[80:95], a[120:123], v[2:5], v[80:95]
    ds_read_b64_tr_b16 v[52:53], v39 offset:5120
    ds_read_b64_tr_b16 v[54:55], v39 offset:5376
    s_waitcnt lgkmcnt(12)
    v_mfma_f32_32x32x16_bf16 v[80:95], a[124:127], v[10:13], v[80:95]
    ds_read_b64_tr_b16 v[2:3], v39 offset:6144
    ds_read_b64_tr_b16 v[4:5], v39 offset:6400
    s_waitcnt lgkmcnt(12)
    v_mfma_f32_32x32x16_bf16 v[64:79], a[128:131], v[6:9], 0
    ds_read_b64_tr_b16 v[10:11], v39 offset:7168
    ds_read_b64_tr_b16 v[12:13], v39 offset:7424
    s_waitcnt lgkmcnt(12)
    v_mfma_f32_32x32x16_bf16 v[64:79], a[132:135], v[14:17], v[64:79]
    ds_read_b64_tr_b16 v[6:7], v39 offset:8192
    ds_read_b64_tr_b16 v[8:9], v39 offset:8448
    s_waitcnt lgkmcnt(12)
    v_mfma_f32_32x32x16_bf16 v[64:79], a[136:139], v[26:29], v[64:79]
    ds_read_b64_tr_b16 v[14:15], v39 offset:9216
    ds_read_b64_tr_b16 v[16:17], v39 offset:9472
    s_waitcnt lgkmcnt(12)
    v_mfma_f32_32x32x16_bf16 v[64:79], a[140:143], v[30:33], v[64:79]
    ds_read_b64_tr_b16 v[26:27], v39 offset:10240
    ds_read_b64_tr_b16 v[28:29], v39 offset:10496
    v_cvt_pk_bf16_f32 v168, v80, v81
    v_cvt_pk_bf16_f32 v169, v82, v83
    v_cvt_pk_bf16_f32 v170, v84, v85
    v_cvt_pk_bf16_f32 v171, v86, v87
    s_waitcnt lgkmcnt(12)
    v_mfma_f32_32x32x16_bf16 v[64:79], a[144:147], v[34:37], v[64:79]
    ds_read_b64_tr_b16 v[30:31], v39 offset:11264
    ds_read_b64_tr_b16 v[32:33], v39 offset:11520
    v_cvt_pk_bf16_f32 v172, v88, v89
    v_cvt_pk_bf16_f32 v173, v90, v91
    v_cvt_pk_bf16_f32 v174, v92, v93
    v_cvt_pk_bf16_f32 v175, v94, v95
    s_waitcnt lgkmcnt(12)
    v_mfma_f32_32x32x16_bf16 v[64:79], a[148:151], v[52:55], v[64:79]
    ds_read_b64_tr_b16 v[34:35], v39 offset:12288
    ds_read_b64_tr_b16 v[36:37], v39 offset:12544
    v_mfma_f32_32x32x16_bf16 v[96:111], v[168:171], v[184:187], v[96:111]
    v_mfma_f32_32x32x16_bf16 v[96:111], v[172:175], v[188:191], v[96:111]
    s_waitcnt lgkmcnt(12)
    v_mfma_f32_32x32x16_bf16 v[64:79], a[152:155], v[2:5], v[64:79]
    ds_read_b64_tr_b16 v[52:53], v39 offset:13312
    ds_read_b64_tr_b16 v[54:55], v39 offset:13568
    s_load_dwordx4 s[52:55], s[50:51], 0 glc
    s_waitcnt lgkmcnt(12)
    v_mfma_f32_32x32x16_bf16 v[64:79], a[156:159], v[10:13], v[64:79]
    ds_read_b64_tr_b16 v[2:3], v39 offset:14336
    ds_read_b64_tr_b16 v[4:5], v39 offset:14592
    s_waitcnt lgkmcnt(12)
    v_mfma_f32_32x32x16_bf16 v[80:95], a[160:163], v[6:9], 0
    ds_read_b64_tr_b16 v[10:11], v39 offset:15360
    ds_read_b64_tr_b16 v[12:13], v39 offset:15616
    s_waitcnt lgkmcnt(12)
    v_mfma_f32_32x32x16_bf16 v[80:95], a[164:167], v[14:17], v[80:95]
    ds_read_b64_tr_b16 v[6:7], v39 offset:16384
    ds_read_b64_tr_b16 v[8:9], v39 offset:16640
    s_waitcnt lgkmcnt(12)
    v_mfma_f32_32x32x16_bf16 v[80:95], a[168:171], v[26:29], v[80:95]
    ds_read_b64_tr_b16 v[14:15], v39 offset:17408
    ds_read_b64_tr_b16 v[16:17], v39 offset:17664
    s_waitcnt lgkmcnt(12)
    v_mfma_f32_32x32x16_bf16 v[80:95], a[172:175], v[30:33], v[80:95]
    ds_read_b64_tr_b16 v[26:27], v39 offset:18432
    ds_read_b64_tr_b16 v[28:29], v39 offset:18688
    v_cvt_pk_bf16_f32 v160, v64, v65
    v_cvt_pk_bf16_f32 v161, v66, v67
    v_cvt_pk_bf16_f32 v162, v68, v69
    v_cvt_pk_bf16_f32 v163, v70, v71
    s_waitcnt lgkmcnt(12)
    v_mfma_f32_32x32x16_bf16 v[80:95], a[176:179], v[34:37], v[80:95]
    ds_read_b64_tr_b16 v[30:31], v39 offset:19456
    ds_read_b64_tr_b16 v[32:33], v39 offset:19712
    v_cvt_pk_bf16_f32 v164, v72, v73
    v_cvt_pk_bf16_f32 v165, v74, v75
    v_cvt_pk_bf16_f32 v166, v76, v77
    v_cvt_pk_bf16_f32 v167, v78, v79
    s_waitcnt lgkmcnt(12)
    v_mfma_f32_32x32x16_bf16 v[80:95], a[180:183], v[52:55], v[80:95]
    ds_read_b64_tr_b16 v[34:35], v39 offset:20480
    ds_read_b64_tr_b16 v[36:37], v39 offset:20736
    v_mfma_f32_32x32x16_bf16 v[96:111], v[160:163], v[192:195], v[96:111]
    s_waitcnt lgkmcnt(0)
    s_branch L_c2
L_c2_ok:
    s_xor_b32 s43, s29, 1
    s_lshl_b32 s43, s43, 13
    s_add_u32 s43, s43, s61
    buffer_load_dwordx4 v[112:115], v44, s[16:19], s43 offen sc1
    buffer_load_dwordx4 v[116:119], v44, s[16:19], s43 offen offset:1024 sc1
    v_mfma_f32_32x32x16_bf16 v[96:111], v[164:167], v[196:199], v[96:111]
    s_xor_b32 s43, s29, 2
    s_lshl_b32 s43, s43, 13
    s_add_u32 s43, s43, s61
    buffer_load_dwordx4 v[120:123], v44, s[16:19], s43 offen sc1
    buffer_load_dwordx4 v[124:127], v44, s[16:19], s43 offen offset:1024 sc1
    s_xor_b32 s43, s29, 3
    s_lshl_b32 s43, s43, 13
    s_add_u32 s43, s43, s61
    v_mfma_f32_32x32x16_bf16 v[80:95], a[184:187], v[2:5], v[80:95]
    ds_read_b64_tr_b16 v[52:53], v39 offset:21504
    ds_read_b64_tr_b16 v[54:55], v39 offset:21760
    buffer_load_dwordx4 v[128:131], v44, s[16:19], s43 offen sc1
    buffer_load_dwordx4 v[132:135], v44, s[16:19], s43 offen offset:1024 sc1
    v_mfma_f32_32x32x16_bf16 v[80:95], a[188:191], v[10:13], v[80:95]
    ds_read_b64_tr_b16 v[2:3], v39 offset:22528
    ds_read_b64_tr_b16 v[4:5], v39 offset:22784
    v_mfma_f32_32x32x16_bf16 v[64:79], a[192:195], v[6:9], 0
    ds_read_b64_tr_b16 v[10:11], v39 offset:23552
    ds_read_b64_tr_b16 v[12:13], v39 offset:23808
    v_mfma_f32_32x32x16_bf16 v[64:79], a[196:199], v[14:17], v[64:79]
    ds_read_b64_tr_b16 v[6:7], v39 offset:24576
    ds_read_b64_tr_b16 v[8:9], v39 offset:24832
    v_mfma_f32_32x32x16_bf16 v[64:79], a[200:203], v[26:29], v[64:79]
    ds_read_b64_tr_b16 v[14:15], v39 offset:25600
    ds_read_b64_tr_b16 v[16:17], v39 offset:25856
    v_mfma_f32_32x32x16_bf16 v[64:79], a[204:207], v[30:33], v[64:79]
    ds_read_b64_tr_b16 v[26:27], v39 offset:26624
    ds_read_b64_tr_b16 v[28:29], v39 offset:26880
    v_cvt_pk_bf16_f32 v168, v80, v81
    v_cvt_pk_bf16_f32 v169, v82, v83
    v_cvt_pk_bf16_f32 v170, v84, v85
    v_cvt_pk_bf16_f32 v171, v86, v87
    v_mfma_f32_32x32x16_bf16 v[64:79], a[208:211], v[34:37], v[64:79]
    ds_read_b64_tr_b16 v[30:31], v39 offset:27648
    ds_read_b64_tr_b16 v[32:33], v39 offset:27904
    v_cvt_pk_bf16_f32 v172, v88, v89
    v_cvt_pk_bf16_f32 v173, v90, v91
    v_cvt_pk_bf16_f32 v174, v92, v93
    v_cvt_pk_bf16_f32 v175, v94, v95
    s_waitcnt lgkmcnt(12)
    v_mfma_f32_32x32x16_bf16 v[64:79], a[212:215], v[52:55], v[64:79]
    ds_read_b64_tr_b16 v[34:35], v39 offset:28672
    ds_read_b64_tr_b16 v[36:37], v39 offset:28928
    v_mfma_f32_32x32x16_bf16 v[96:111], v[168:171], v[200:203], v[96:111]
    v_mfma_f32_32x32x16_bf16 v[96:111], v[172:175], v[204:207], v[96:111]
    s_waitcnt lgkmcnt(12)
    v_mfma_f32_32x32x16_bf16 v[64:79], a[216:219], v[2:5], v[64:79]
    ds_read_b64_tr_b16 v[52:53], v39 offset:29696
    ds_read_b64_tr_b16 v[54:55], v39 offset:29952
    s_waitcnt lgkmcnt(12)
    v_mfma_f32_32x32x16_bf16 v[64:79], a[220:223], v[10:13], v[64:79]
    ds_read_b64_tr_b16 v[2:3], v39 offset:30720
    ds_read_b64_tr_b16 v[4:5], v39 offset:30976
    s_waitcnt lgkmcnt(12)
    v_mfma_f32_32x32x16_bf16 v[80:95], a[224:227], v[6:9], 0
    ds_read_b64_tr_b16 v[10:11], v39 offset:31744
    ds_read_b64_tr_b16 v[12:13], v39 offset:32000
    s_waitcnt lgkmcnt(12)
    v_mfma_f32_32x32x16_bf16 v[80:95], a[228:231], v[14:17], v[80:95]
    s_waitcnt lgkmcnt(10)
    v_mfma_f32_32x32x16_bf16 v[80:95], a[232:235], v[26:29], v[80:95]
    s_waitcnt lgkmcnt(8)
    v_mfma_f32_32x32x16_bf16 v[80:95], a[236:239], v[30:33], v[80:95]
    s_nop 3
    v_cvt_pk_bf16_f32 v160, v64, v65
    v_cvt_pk_bf16_f32 v161, v66, v67
    v_cvt_pk_bf16_f32 v162, v68, v69
    v_cvt_pk_bf16_f32 v163, v70, v71
    s_waitcnt lgkmcnt(6)
    v_mfma_f32_32x32x16_bf16 v[80:95], a[240:243], v[34:37], v[80:95]
    v_cvt_pk_bf16_f32 v164, v72, v73
    v_cvt_pk_bf16_f32 v165, v74, v75
    v_cvt_pk_bf16_f32 v166, v76, v77
    v_cvt_pk_bf16_f32 v167, v78, v79
    s_waitcnt lgkmcnt(4)
    v_mfma_f32_32x32x16_bf16 v[80:95], a[244:247], v[52:55], v[80:95]
    v_mfma_f32_32x32x16_bf16 v[96:111], v[160:163], v[208:211], v[96:111]
    v_mfma_f32_32x32x16_bf16 v[96:111], v[164:167], v[212:215], v[96:111]
    s_waitcnt lgkmcnt(2)
    v_mfma_f32_32x32x16_bf16 v[80:95], a[248:251], v[2:5], v[80:95]
    s_waitcnt lgkmcnt(0)
    v_mfma_f32_32x32x16_bf16 v[80:95], a[252:255], v[10:13], v[80:95]
    s_waitcnt vmcnt(4)
    v_lshlrev_b32 v136, 16, v112
    v_and_b32 v137, 0xffff0000, v112
    v_lshlrev_b32 v138, 16, v113
    v_and_b32 v139, 0xffff0000, v113
    v_lshlrev_b32 v140, 16, v114
    v_and_b32 v141, 0xffff0000, v114
    v_lshlrev_b32 v142, 16, v115
    v_and_b32 v143, 0xffff0000, v115
    s_nop 2
    v_cvt_pk_bf16_f32 v168, v80, v81
    v_cvt_pk_bf16_f32 v169, v82, v83
    v_cvt_pk_bf16_f32 v170, v84, v85
    v_cvt_pk_bf16_f32 v171, v86, v87
    v_cvt_pk_bf16_f32 v172, v88, v89
    v_cvt_pk_bf16_f32 v173, v90, v91
    v_cvt_pk_bf16_f32 v174, v92, v93
    v_cvt_pk_bf16_f32 v175, v94, v95
    v_lshlrev_b32 v144, 16, v116
    v_and_b32 v145, 0xffff0000, v116
    v_lshlrev_b32 v146, 16, v117
    v_and_b32 v147, 0xffff0000, v117
    v_lshlrev_b32 v148, 16, v118
    v_and_b32 v149, 0xffff0000, v118
    v_lshlrev_b32 v150, 16, v119
    v_and_b32 v151, 0xffff0000, v119
    v_mfma_f32_32x32x16_bf16 v[96:111], v[168:171], v[216:219], v[96:111]
    v_mfma_f32_32x32x16_bf16 v[96:111], v[172:175], v[220:223], v[96:111]
    s_waitcnt vmcnt(2)
    v_lshlrev_b32 v50, 16, v120
    v_and_b32 v51, 0xffff0000, v120
    v_add_f32 v136, v136, v50
    v_add_f32 v137, v137, v51
    v_lshlrev_b32 v50, 16, v121
    v_and_b32 v51, 0xffff0000, v121
    v_add_f32 v138, v138, v50
    v_add_f32 v139, v139, v51
    v_lshlrev_b32 v50, 16, v122
    v_and_b32 v51, 0xffff0000, v122
    v_add_f32 v140, v140, v50
    v_add_f32 v141, v141, v51
    v_lshlrev_b32 v50, 16, v123
    v_and_b32 v51, 0xffff0000, v123
    v_add_f32 v142, v142, v50
    v_add_f32 v143, v143, v51
    v_lshlrev_b32 v50, 16, v124
    v_and_b32 v51, 0xffff0000, v124
    v_add_f32 v144, v144, v50
    v_add_f32 v145, v145, v51
    v_lshlrev_b32 v50, 16, v125
    v_and_b32 v51, 0xffff0000, v125
    v_add_f32 v146, v146, v50
    v_add_f32 v147, v147, v51
    v_lshlrev_b32 v50, 16, v126
    v_and_b32 v51, 0xffff0000, v126
    v_add_f32 v148, v148, v50
    v_add_f32 v149, v149, v51
    v_lshlrev_b32 v50, 16, v127
    v_and_b32 v51, 0xffff0000, v127
    v_add_f32 v150, v150, v50
    v_add_f32 v151, v151, v51
    s_waitcnt vmcnt(0)
    v_lshlrev_b32 v50, 16, v128
    v_and_b32 v51, 0xffff0000, v128
    v_add_f32 v136, v136, v50
    v_add_f32 v137, v137, v51
    v_lshlrev_b32 v50, 16, v129
    v_and_b32 v51, 0xffff0000, v129
    v_add_f32 v138, v138, v50
    v_add_f32 v139, v139, v51
    v_lshlrev_b32 v50, 16, v130
    v_and_b32 v51, 0xffff0000, v130
    v_add_f32 v140, v140, v50
    v_add_f32 v141, v141, v51
    v_lshlrev_b32 v50, 16, v131
    v_and_b32 v51, 0xffff0000, v131
    v_add_f32 v142, v142, v50
    v_add_f32 v143, v143, v51
    v_lshlrev_b32 v50, 16, v132
    v_and_b32 v51, 0xffff0000, v132
    v_add_f32 v144, v144, v50
    v_add_f32 v145, v145, v51
    v_lshlrev_b32 v50, 16, v133
    v_and_b32 v51, 0xffff0000, v133
    v_add_f32 v146, v146, v50
    v_add_f32 v147, v147, v51
    v_lshlrev_b32 v50, 16, v134
    v_and_b32 v51, 0xffff0000, v134
    v_add_f32 v148, v148, v50
    v_add_f32 v149, v149, v51
    v_lshlrev_b32 v50, 16, v135
    v_and_b32 v51, 0xffff0000, v135
    v_add_f32 v150, v150, v50
    v_add_f32 v151, v151, v51
    v_add_f32 v136, v136, v96
    v_add_f32 v137, v137, v97
    v_cvt_pk_bf16_f32 v112, v136, v137
    v_add_f32 v138, v138, v98
    v_add_f32 v139, v139, v99
    v_cvt_pk_bf16_f32 v113, v138, v139
    v_add_f32 v140, v140, v100
    v_add_f32 v141, v141, v101
    v_cvt_pk_bf16_f32 v114, v140, v141
    v_add_f32 v142, v142, v102
    v_add_f32 v143, v143, v103
    v_cvt_pk_bf16_f32 v115, v142, v143
    v_add_f32 v144, v144, v104
    v_add_f32 v145, v145, v105
    v_cvt_pk_bf16_f32 v116, v144, v145
    v_add_f32 v146, v146, v106
    v_add_f32 v147, v147, v107
    v_cvt_pk_bf16_f32 v117, v146, v147
    v_add_f32 v148, v148, v108
    v_add_f32 v149, v149, v109
    v_cvt_pk_bf16_f32 v118, v148, v149
    v_add_f32 v150, v150, v110
    v_add_f32 v151, v151, v111
    v_cvt_pk_bf16_f32 v119, v150, v151
    buffer_store_dwordx4 v[112:115], v48, s[20:23], s34 offen
    buffer_store_dwordx4 v[116:119], v48, s[20:23], s34 offen offset:32
    s_endpgm
L_kev0:
    s_mov_b32 m0, s5
    s_add_u32 s5, s5, 4096
    buffer_load_dwordx4 v30, s[24:27], s4 offen offset:0 nt lds
    buffer_load_dwordx4 v31, s[24:27], s4 offen offset:1024 nt lds
    buffer_load_dwordx4 v32, s[24:27], s4 offen offset:2048 nt lds
    buffer_load_dwordx4 v33, s[24:27], s4 offen offset:3072 nt lds
    s_add_u32 s4, s4, 4096
    s_branch L_kev0_back
L_kev1:
    s_mov_b32 m0, s5
    s_add_u32 s5, s5, 4096
    buffer_load_dwordx4 v30, s[24:27], s4 offen offset:0 nt lds
    buffer_load_dwordx4 v31, s[24:27], s4 offen offset:1024 nt lds
    buffer_load_dwordx4 v32, s[24:27], s4 offen offset:2048 nt lds
    buffer_load_dwordx4 v33, s[24:27], s4 offen offset:3072 nt lds
    s_add_u32 s4, s4, 4096
    s_branch L_kev1_back
L_kev2:
    s_mov_b32 m0, s5
    s_add_u32 s5, s5, 4096
    buffer_load_dwordx4 v30, s[24:27], s4 offen offset:0 nt lds
    buffer_load_dwordx4 v31, s[24:27], s4 offen offset:1024 nt lds
    buffer_load_dwordx4 v32, s[24:27], s4 offen offset:2048 nt lds
    buffer_load_dwordx4 v33, s[24:27], s4 offen offset:3072 nt lds
    s_add_u32 s4, s4, 4096
    s_branch L_kev2_back
L_kev3:
    s_mov_b32 m0, s5
    s_add_u32 s5, s5, 4096
    buffer_load_dwordx4 v30, s[24:27], s4 offen offset:0 nt lds
    buffer_load_dwordx4 v31, s[24:27], s4 offen offset:1024 nt lds
    buffer_load_dwordx4 v32, s[24:27], s4 offen offset:2048 nt lds
    buffer_load_dwordx4 v33, s[24:27], s4 offen offset:3072 nt lds
    s_add_u32 s4, s4, 4096
    s_branch L_kev3_back
L_leader:
    s_load_dword s3, s[84:85], 0 glc
    s_waitcnt lgkmcnt(0)
    s_add_u32 s3, s3, 1
    s_max_u32 s3, s3, 1
    v_mov_b32 v250, s3
    v_mov_b32 v251, 0
    s_mov_b64 exec, 1
    global_store_dword v251, v250, s[82:83] sc1
    global_store_dword v251, v250, s[84:85] sc1
    s_mov_b64 exec, -1
    s_branch L_noleader
L_nonce_spin:
    s_add_u32 s3, s3, 1
    s_cmp_gt_u32 s3, 0x100000
    s_cbranch_scc1 L_end
    v_mov_b32 v50, 0
    global_load_dword v45, v50, s[82:83] sc1
    s_waitcnt vmcnt(0)
    v_readfirstlane_b32 s44, v45
    s_nop 3
    s_cmp_eq_u32 s44, 0
    s_cbranch_scc1 L_nonce_spin
    s_branch L_nonce_ok
L_chk:
    s_cmp_lg_u32 s52, s44
    s_cbranch_scc1 L_chk_again
    s_cmp_lg_u32 s53, s44
    s_cbranch_scc1 L_chk_again
    s_cmp_lg_u32 s54, s44
    s_cbranch_scc1 L_chk_again
    s_cmp_lg_u32 s55, s44
    s_cbranch_scc1 L_chk_again
    s_cmp_lg_u32 s56, s44
    s_cbranch_scc1 L_chk_again
    s_cmp_lg_u32 s57, s44
    s_cbranch_scc1 L_chk_again
    s_cmp_lg_u32 s58, s44
    s_cbranch_scc1 L_chk_again
    s_cmp_lg_u32 s59, s44
    s_cbranch_scc1 L_chk_again
    s_branch L_chk_ok
L_chk_again:
    s_add_u32 s3, s3, 1
    s_cmp_gt_u32 s3, 0x100000
    s_cbranch_scc1 L_end
    s_load_dwordx8 s[52:59], s[48:49], 0 glc
    s_waitcnt lgkmcnt(0)
    s_branch L_chk
L_c2:
    s_mov_b32 s35, 0
    s_cmp_eq_u32 s52, s44
    s_addc_u32 s35, s35, s35
    s_cmp_eq_u32 s53, s44
    s_addc_u32 s35, s35, s35
    s_cmp_eq_u32 s54, s44
    s_addc_u32 s35, s35, s35
    s_cmp_eq_u32 s55, s44
    s_addc_u32 s35, s35, s35
    s_lshr_b32 s38, 8, s29
    s_or_b32 s35, s35, s38
    s_cmp_eq_u32 s35, 15
    s_cbranch_scc1 L_c2_ok
    s_add_u32 s3, s3, 1
    s_cmp_gt_u32 s3, 0x100000
    s_cbranch_scc1 L_end
    s_load_dwordx4 s[52:55], s[50:51], 0 glc
    s_waitcnt lgkmcnt(0)
    s_branch L_c2
L_end:
    s_endpgm

.section .rodata,"a"
.p2align 6
.amdhsa_kernel concat_heads__mha_block_cached__mha_block_cached__near_ridge_kernel
  .amdhsa_next_free_vgpr 512
  .amdhsa_next_free_sgpr 102
  .amdhsa_accum_offset 256
  .amdhsa_group_segment_fixed_size 0
  .amdhsa_kernarg_size 104
  .amdhsa_user_sgpr_count 2
  .amdhsa_user_sgpr_kernarg_segment_ptr 1
  .amdhsa_system_sgpr_workgroup_id_x 1

.end_amdhsa_kernel
```
